```python
import torch

def _softmax(x, axis=-1):
    return torch.softmax(x, dim=axis)
def _gelu(x):
    return torch.nn.functional.gelu(x, approximate="tanh")
def _silu(x):
    return torch.nn.functional.silu(x)
def _sigmoid(x):
    return torch.sigmoid(x)
def _layernorm(x, axis=-1, eps=1e-5):
    m = x.mean(dim=axis, keepdim=True)
    v = x.var(dim=axis, keepdim=True, unbiased=False)
    return (x - m) / torch.sqrt(v + eps)
def _scatter_add(tgt, idx, src, axis=0):
    return tgt.clone().index_add_(axis, idx, src)
def _segment_sum(src, seg, n):
    out = torch.zeros((n,) + src.shape[1:], dtype=src.dtype)
    return out.index_add_(0, seg, src)
def _pad(x, pw):
    flat = tuple(v for pair in reversed(pw) for v in pair)
    return torch.nn.functional.pad(x, flat)

kernel_name = 'interleave_layers__ssm_conv_h3__glu_gated_geglu__prompt'

def setup_inputs():

    _w = (lambda a: (lambda t: t.to(torch.bfloat16) if t.is_floating_point() else t)(torch.as_tensor(a)))
    def _A_setup():
        B, S, D = 1, 2048, 640
        ks = 4
        return {
            "q": _w((lambda *s: torch.randn(*s, dtype=torch.bfloat16) * 0.05)(B, S, D)),
            "k": _w((lambda *s: torch.randn(*s, dtype=torch.bfloat16) * 0.2)(B, S, D)),
            "v": _w((lambda *s: torch.randn(*s, dtype=torch.bfloat16) * 0.2)(B, S, D)),
            "shift_k": _w((lambda *s: torch.randn(*s, dtype=torch.bfloat16) * 0.2)(D, ks) * 0.5),
            "ssm_k": _w((lambda *s: torch.randn(*s, dtype=torch.bfloat16) * 0.4)(D, S) * (1.0 / S ** 0.5)),
            "ssm_D": _w((lambda *s: torch.randn(*s, dtype=torch.bfloat16) * 0.2)(D)),
        }
    _A_in = _A_setup()

    def _B_setup():
        B, S, Dm, Df = 1, 2048, 640, 1536
        return {
            "x": _w((lambda *s: torch.randn(*s, dtype=torch.bfloat16) * 0.05)(B, S, Dm)),
            "w_gate": _w((lambda *s: torch.randn(*s, dtype=torch.bfloat16) * 0.4)(Dm, Df) * (Dm ** -0.5)),
            "w_up": _w((lambda *s: torch.randn(*s, dtype=torch.bfloat16) * 0.4)(Dm, Df) * (Dm ** -0.5)),
            "w_down": _w((lambda *s: torch.randn(*s, dtype=torch.bfloat16) * 0.4)(Df, Dm) * (Df ** -0.5)),
        }
    _B_in = _B_setup()

    return {
        "A_q": _A_in["q"],
        "A_k": _A_in["k"],
        "A_v": _A_in["v"],
        "A_shift_k": _A_in["shift_k"],
        "A_ssm_k": _A_in["ssm_k"],
        "A_ssm_D": _A_in["ssm_D"],
        "B_x": _B_in["x"],
        "B_w_gate": _B_in["w_gate"],
        "B_w_up": _B_in["w_up"],
        "B_w_down": _B_in["w_down"],
    }

def reference(A_q, A_k, A_v, A_shift_k, A_ssm_k, A_ssm_D, B_x, B_w_gate, B_w_up, B_w_down):
    def _A_ref(q, k, v, shift_k, ssm_k, ssm_D):
        B, S, D = q.shape
        ks = shift_k.shape[-1]
        k_pad = _pad(k, ((0, 0), (ks - 1, 0), (0, 0)))
        k_shift = torch.zeros_like(k)
        for t in range(ks):
            k_shift = k_shift + k_pad[:, t:t + S, :] * shift_k[:, ks - 1 - t][None, None, :]
        kv = k_shift * v
        L = 2 * S
        kv_pad = _pad(kv, ((0, 0), (0, S), (0, 0)))
        kf_pad = _pad(ssm_k, ((0, 0), (0, S)))
        kv_f = (lambda x, axes=(-2,-1): torch.fft.rfft2(x.float(), dim=axes))(kv_pad[:, None, :, :], axes=(1, 2))
        kf_f = (lambda x, axes=(-2,-1): torch.fft.rfft2(x.float(), dim=axes))(kf_pad[:, None, :], axes=(1, 2))
        kf_f = (lambda x, *d: x.permute(*d))(kf_f, 1, 2, 0)
        y_f = kv_f * kf_f[None, :, :, :]
        y = (lambda x, s, axes=(-2,-1): torch.fft.irfft2(x, s=s, dim=axes).to(torch.bfloat16))(y_f, (1, L), axes=(1, 2))[:, 0, :S, :]
        y = y + kv * ssm_D[None, None, :]
        return q * y

    def _B_ref(x, w_gate, w_up, w_down):
        g = torch.einsum("bsd,df->bsf", x, w_gate)
        u = torch.einsum("bsd,df->bsf", x, w_up)
        h = _gelu(g) * u
        return torch.einsum("bsf,fd->bsd", h, w_down)

    x = A_q
    x = x + _A_ref(_layernorm(x, axis=-1), A_k, A_v, A_shift_k, A_ssm_k, A_ssm_D)
    x = x + _B_ref(_layernorm(x, axis=-1), B_w_gate, B_w_up, B_w_down)
    x = x + _A_ref(_layernorm(x, axis=-1), A_k, A_v, A_shift_k, A_ssm_k, A_ssm_D)
    x = x + _B_ref(_layernorm(x, axis=-1), B_w_gate, B_w_up, B_w_down)
    return x
```

```asm
; @launch grid=(256,1,1) block=(256,1,1) lds=163840
.amdgcn_target "amdgcn-amd-amdhsa--gfx950"
.text
.globl interleave_layers__ssm_conv_h3__glu_gated_geglu__prompt_kernel
.p2align 8
.type interleave_layers__ssm_conv_h3__glu_gated_geglu__prompt_kernel,@function
interleave_layers__ssm_conv_h3__glu_gated_geglu__prompt_kernel:
    s_cmp_ge_u32 s2, 256
    s_cbranch_scc1 L_end
    s_load_dwordx16 s[16:31], s[0:1], 0
    s_load_dwordx8 s[32:39], s[0:1], 64
    s_load_dwordx2 s[40:41], s[0:1], 96
    v_lshrrev_b32 v2, 6, v0
    v_and_b32 v1, 63, v0
    v_readfirstlane_b32 s3, v2
    s_and_b32 s4, s2, 7
    s_lshr_b32 s5, s2, 3
    s_getreg_b32 s7, hwreg(HW_REG_XCC_ID, 0, 4)
    s_mov_b32 s12, 0
    s_mov_b32 s13, 0
    s_mov_b32 s80, 65536
    s_mov_b32 s14, 0x500000
    s_mov_b32 s15, 0x1000000
    s_mov_b32 s42, 0xe64000
    s_getpc_b64 s[64:65]
    s_lshl_b32 s66, s5, 4
    v_and_b32 v3, 15, v0
    v_add_lshl_u32 v3, v3, s66, 7
    v_min_u32 v3, CODE_SPAN, v3
    s_cmp_lg_u32 s3, 2
    s_cbranch_scc1 L_nocpf
    global_load_dword v255, v3, s[64:65]
L_nocpf:
    s_waitcnt lgkmcnt(0)
    s_mov_b32 s8, s40
    s_and_b32 s9, s41, 0xffff
    s_mov_b32 s10, 0x10000000
    s_mov_b32 s11, 0x20000
    s_cmp_eq_u32 s3, 3
    s_cbranch_scc1 L_loader
    s_mov_b32 s44, s18
    s_and_b32 s45, s19, 0xffff
    s_mov_b32 s46, 0x280000
    s_mov_b32 s47, 0x20000
    s_mov_b32 s48, s20
    s_and_b32 s49, s21, 0xffff
    s_mov_b32 s50, 0x280000
    s_mov_b32 s51, 0x20000
    s_mov_b32 s56, s22
    s_and_b32 s57, s23, 0xffff
    s_mov_b32 s58, 0x1400
    s_mov_b32 s59, 0x20000
    v_and_b32 v2, 3, v1
    v_lshrrev_b32 v3, 2, v1
    s_lshl_b32 s64, s3, 2
    v_add_u32 v4, s64, v2
    v_min_u32 v4, 9, v4
    s_mul_i32 s65, s4, 80
    v_lshl_add_u32 v4, v4, 3, s65
    s_mul_i32 s66, s5, 81920
    v_mul_u32_u24 v5, 5120, v3
    v_lshl_add_u32 v5, v4, 1, v5
    v_add_u32 v5, s66, v5
    v_subrev_u32 v6, 3840, v5
    v_lshlrev_b32 v7, 3, v4
    buffer_load_dwordx4 v[28:31], v5, s[44:47], 0 offen offset:0
    buffer_load_dwordx4 v[32:35], v5, s[44:47], 0 offen offset:1280
    buffer_load_dwordx4 v[36:39], v5, s[44:47], 0 offen offset:2560
    buffer_load_dwordx4 v[40:43], v5, s[44:47], 0 offen offset:3840
    buffer_load_dwordx4 v[44:47], v5, s[48:51], 0 offen offset:0
    buffer_load_dwordx4 v[48:51], v5, s[48:51], 0 offen offset:1280
    buffer_load_dwordx4 v[52:55], v5, s[48:51], 0 offen offset:2560
    buffer_load_dwordx4 v[56:59], v5, s[48:51], 0 offen offset:3840
    buffer_load_dwordx4 v[16:19], v6, s[44:47], 0 offen offset:0
    buffer_load_dwordx4 v[20:23], v6, s[44:47], 0 offen offset:1280
    buffer_load_dwordx4 v[24:27], v6, s[44:47], 0 offen offset:2560
    buffer_load_dwordx4 v[76:79], v7, s[56:59], 0 offen offset:0
    buffer_load_dwordx4 v[80:83], v7, s[56:59], 0 offen offset:16
    buffer_load_dwordx4 v[84:87], v7, s[56:59], 0 offen offset:32
    buffer_load_dwordx4 v[88:91], v7, s[56:59], 0 offen offset:48
    s_barrier
    s_mov_b32 s52, s38
    s_and_b32 s53, s39, 0xffff
    s_mov_b32 s54, 0x100
    s_mov_b32 s55, 0x20000
    s_mov_b32 s60, s24
    s_and_b32 s61, s25, 0xffff
    s_mov_b32 s62, 0x280000
    s_mov_b32 s63, 0x20000
    s_mul_i32 s67, s5, 3
    s_add_u32 s67, s67, s3
    s_min_u32 s68, s67, 79
    s_add_u32 s68, s65, s68
    v_lshlrev_b32 v7, 4, v1
    s_mul_i32 s69, s3, 4224
    s_add_u32 s69, s69, 147456
    s_and_b32 s71, s68, -2
    s_lshl_b32 s71, s71, 1
    s_load_dword s72, s[26:27], s71
    v_mov_b32 v8, 0
    v_mov_b32 v9, 0
    v_lshlrev_b32 v10, 3, v1
    v_add_u32 v10, s69, v10
    s_mov_b64 exec, 15
    ds_write_b64 v10, v[8:9]
    s_mov_b64 exec, -1
    s_mov_b32 s86, 0x05040100
    s_mov_b32 s87, 0x07060302
    s_mov_b32 s64, 0xffff0000
    s_lshl_b32 s66, s3, 13
    s_add_u32 s66, s66, 122880
    v_lshrrev_b32 v8, 1, v3
    v_lshlrev_b32 v9, 1, v2
    v_xor_b32 v8, v8, v9
    v_lshlrev_b32 v8, 4, v8
    v_and_b32 v9, 1, v3
    v_lshl_add_u32 v8, v9, 3, v8
    v_lshl_add_u32 v8, v2, 10, v8
    v_add_u32 v8, s66, v8
    v_lshrrev_b32 v9, 3, v1
    v_and_b32 v10, 7, v1
    v_lshlrev_b32 v11, 7, v9
    v_add_u32 v11, s66, v11
    s_lshl_b32 s70, s3, 5
    s_add_u32 s70, s70, s65
    v_add_u32 v12, s70, v9
    v_lshlrev_b32 v12, 12, v12
    v_lshl_add_u32 v12, v10, 4, v12
    s_lshl_b32 s70, s5, 7
    v_add_u32 v12, s70, v12
    s_waitcnt lgkmcnt(0)
    s_bitcmp1_b32 s68, 0
    s_cselect_b32 s70, 0, 16
    s_lshl_b32 s72, s72, s70
    s_and_b32 s72, s72, 0xffff0000
    s_mov_b32 s73, s72
    s_lshl_b32 s83, s4, 3
    s_waitcnt vmcnt(14)
    s_load_dwordx2 s[84:85], s[38:39], s83
    s_waitcnt vmcnt(0)
    v_perm_b32 v96, v16, v20, s86
    v_perm_b32 v97, v20, v24, s86
    v_perm_b32 v98, v24, v28, s86
    v_perm_b32 v99, v28, v32, s86
    v_perm_b32 v100, v32, v36, s86
    v_perm_b32 v101, v36, v40, s86
    v_perm_b32 v104, v16, v20, s87
    v_perm_b32 v105, v20, v24, s87
    v_perm_b32 v106, v24, v28, s87
    v_perm_b32 v107, v28, v32, s87
    v_perm_b32 v108, v32, v36, s87
    v_perm_b32 v109, v36, v40, s87
    v_dot2_f32_bf16 v112, v96, v77, 0
    v_dot2_f32_bf16 v114, v97, v77, 0
    v_dot2_f32_bf16 v116, v98, v77, 0
    v_dot2_f32_bf16 v118, v99, v77, 0
    v_dot2_f32_bf16 v113, v104, v79, 0
    v_dot2_f32_bf16 v115, v105, v79, 0
    v_dot2_f32_bf16 v117, v106, v79, 0
    v_dot2_f32_bf16 v119, v107, v79, 0
    v_lshlrev_b32 v128, 16, v44
    v_and_b32 v129, s64, v44
    v_lshlrev_b32 v130, 16, v48
    v_and_b32 v131, s64, v48
    v_lshlrev_b32 v132, 16, v52
    v_and_b32 v133, s64, v52
    v_lshlrev_b32 v134, 16, v56
    v_and_b32 v135, s64, v56
    v_dot2_f32_bf16 v112, v98, v76, v112
    v_dot2_f32_bf16 v114, v99, v76, v114
    v_dot2_f32_bf16 v116, v100, v76, v116
    v_dot2_f32_bf16 v118, v101, v76, v118
    v_dot2_f32_bf16 v113, v106, v78, v113
    v_dot2_f32_bf16 v115, v107, v78, v115
    v_dot2_f32_bf16 v117, v108, v78, v117
    v_dot2_f32_bf16 v119, v109, v78, v119
    s_nop 1
    v_pk_mul_f32 v[112:113], v[112:113], v[128:129]
    v_pk_mul_f32 v[114:115], v[114:115], v[130:131]
    v_pk_mul_f32 v[116:117], v[116:117], v[132:133]
    v_pk_mul_f32 v[118:119], v[118:119], v[134:135]
    v_cvt_pk_bf16_f32 v144, v112, v114
    v_cvt_pk_bf16_f32 v145, v116, v118
    v_cvt_pk_bf16_f32 v146, v113, v115
    v_cvt_pk_bf16_f32 v147, v117, v119
    ds_write_b64 v8, v[144:145] offset:0
    ds_write_b64 v8, v[146:147] offset:128
    v_perm_b32 v96, v17, v21, s86
    v_perm_b32 v97, v21, v25, s86
    v_perm_b32 v98, v25, v29, s86
    v_perm_b32 v99, v29, v33, s86
    v_perm_b32 v100, v33, v37, s86
    v_perm_b32 v101, v37, v41, s86
    v_perm_b32 v104, v17, v21, s87
    v_perm_b32 v105, v21, v25, s87
    v_perm_b32 v106, v25, v29, s87
    v_perm_b32 v107, v29, v33, s87
    v_perm_b32 v108, v33, v37, s87
    v_perm_b32 v109, v37, v41, s87
    v_dot2_f32_bf16 v112, v96, v81, 0
    v_dot2_f32_bf16 v114, v97, v81, 0
    v_dot2_f32_bf16 v116, v98, v81, 0
    v_dot2_f32_bf16 v118, v99, v81, 0
    v_dot2_f32_bf16 v113, v104, v83, 0
    v_dot2_f32_bf16 v115, v105, v83, 0
    v_dot2_f32_bf16 v117, v106, v83, 0
    v_dot2_f32_bf16 v119, v107, v83, 0
    v_lshlrev_b32 v128, 16, v45
    v_and_b32 v129, s64, v45
    v_lshlrev_b32 v130, 16, v49
    v_and_b32 v131, s64, v49
    v_lshlrev_b32 v132, 16, v53
    v_and_b32 v133, s64, v53
    v_lshlrev_b32 v134, 16, v57
    v_and_b32 v135, s64, v57
    v_dot2_f32_bf16 v112, v98, v80, v112
    v_dot2_f32_bf16 v114, v99, v80, v114
    v_dot2_f32_bf16 v116, v100, v80, v116
    v_dot2_f32_bf16 v118, v101, v80, v118
    v_dot2_f32_bf16 v113, v106, v82, v113
    v_dot2_f32_bf16 v115, v107, v82, v115
    v_dot2_f32_bf16 v117, v108, v82, v117
    v_dot2_f32_bf16 v119, v109, v82, v119
    s_nop 1
    v_pk_mul_f32 v[112:113], v[112:113], v[128:129]
    v_pk_mul_f32 v[114:115], v[114:115], v[130:131]
    v_pk_mul_f32 v[116:117], v[116:117], v[132:133]
    v_pk_mul_f32 v[118:119], v[118:119], v[134:135]
    v_cvt_pk_bf16_f32 v148, v112, v114
    v_cvt_pk_bf16_f32 v149, v116, v118
    v_cvt_pk_bf16_f32 v150, v113, v115
    v_cvt_pk_bf16_f32 v151, v117, v119
    ds_write_b64 v8, v[148:149] offset:256
    ds_write_b64 v8, v[150:151] offset:384
    v_perm_b32 v96, v18, v22, s86
    v_perm_b32 v97, v22, v26, s86
    v_perm_b32 v98, v26, v30, s86
    v_perm_b32 v99, v30, v34, s86
    v_perm_b32 v100, v34, v38, s86
    v_perm_b32 v101, v38, v42, s86
    v_perm_b32 v104, v18, v22, s87
    v_perm_b32 v105, v22, v26, s87
    v_perm_b32 v106, v26, v30, s87
    v_perm_b32 v107, v30, v34, s87
    v_perm_b32 v108, v34, v38, s87
    v_perm_b32 v109, v38, v42, s87
    v_dot2_f32_bf16 v112, v96, v85, 0
    v_dot2_f32_bf16 v114, v97, v85, 0
    v_dot2_f32_bf16 v116, v98, v85, 0
    v_dot2_f32_bf16 v118, v99, v85, 0
    v_dot2_f32_bf16 v113, v104, v87, 0
    v_dot2_f32_bf16 v115, v105, v87, 0
    v_dot2_f32_bf16 v117, v106, v87, 0
    v_dot2_f32_bf16 v119, v107, v87, 0
    v_lshlrev_b32 v128, 16, v46
    v_and_b32 v129, s64, v46
    v_lshlrev_b32 v130, 16, v50
    v_and_b32 v131, s64, v50
    v_lshlrev_b32 v132, 16, v54
    v_and_b32 v133, s64, v54
    v_lshlrev_b32 v134, 16, v58
    v_and_b32 v135, s64, v58
    v_dot2_f32_bf16 v112, v98, v84, v112
    v_dot2_f32_bf16 v114, v99, v84, v114
    v_dot2_f32_bf16 v116, v100, v84, v116
    v_dot2_f32_bf16 v118, v101, v84, v118
    v_dot2_f32_bf16 v113, v106, v86, v113
    v_dot2_f32_bf16 v115, v107, v86, v115
    v_dot2_f32_bf16 v117, v108, v86, v117
    v_dot2_f32_bf16 v119, v109, v86, v119
    s_nop 1
    v_pk_mul_f32 v[112:113], v[112:113], v[128:129]
    v_pk_mul_f32 v[114:115], v[114:115], v[130:131]
    v_pk_mul_f32 v[116:117], v[116:117], v[132:133]
    v_pk_mul_f32 v[118:119], v[118:119], v[134:135]
    v_cvt_pk_bf16_f32 v144, v112, v114
    v_cvt_pk_bf16_f32 v145, v116, v118
    v_cvt_pk_bf16_f32 v146, v113, v115
    v_cvt_pk_bf16_f32 v147, v117, v119
    ds_write_b64 v8, v[144:145] offset:512
    ds_write_b64 v8, v[146:147] offset:640
    v_perm_b32 v96, v19, v23, s86
    v_perm_b32 v97, v23, v27, s86
    v_perm_b32 v98, v27, v31, s86
    v_perm_b32 v99, v31, v35, s86
    v_perm_b32 v100, v35, v39, s86
    v_perm_b32 v101, v39, v43, s86
    v_perm_b32 v104, v19, v23, s87
    v_perm_b32 v105, v23, v27, s87
    v_perm_b32 v106, v27, v31, s87
    v_perm_b32 v107, v31, v35, s87
    v_perm_b32 v108, v35, v39, s87
    v_perm_b32 v109, v39, v43, s87
    v_dot2_f32_bf16 v112, v96, v89, 0
    v_dot2_f32_bf16 v114, v97, v89, 0
    v_dot2_f32_bf16 v116, v98, v89, 0
    v_dot2_f32_bf16 v118, v99, v89, 0
    v_dot2_f32_bf16 v113, v104, v91, 0
    v_dot2_f32_bf16 v115, v105, v91, 0
    v_dot2_f32_bf16 v117, v106, v91, 0
    v_dot2_f32_bf16 v119, v107, v91, 0
    v_lshlrev_b32 v128, 16, v47
    v_and_b32 v129, s64, v47
    v_lshlrev_b32 v130, 16, v51
    v_and_b32 v131, s64, v51
    v_lshlrev_b32 v132, 16, v55
    v_and_b32 v133, s64, v55
    v_lshlrev_b32 v134, 16, v59
    v_and_b32 v135, s64, v59
    v_dot2_f32_bf16 v112, v98, v88, v112
    v_dot2_f32_bf16 v114, v99, v88, v114
    v_dot2_f32_bf16 v116, v100, v88, v116
    v_dot2_f32_bf16 v118, v101, v88, v118
    v_dot2_f32_bf16 v113, v106, v90, v113
    v_dot2_f32_bf16 v115, v107, v90, v115
    v_dot2_f32_bf16 v117, v108, v90, v117
    v_dot2_f32_bf16 v119, v109, v90, v119
    s_nop 1
    v_pk_mul_f32 v[112:113], v[112:113], v[128:129]
    v_pk_mul_f32 v[114:115], v[114:115], v[130:131]
    v_pk_mul_f32 v[116:117], v[116:117], v[132:133]
    v_pk_mul_f32 v[118:119], v[118:119], v[134:135]
    v_cvt_pk_bf16_f32 v148, v112, v114
    v_cvt_pk_bf16_f32 v149, v116, v118
    v_cvt_pk_bf16_f32 v150, v113, v115
    v_cvt_pk_bf16_f32 v151, v117, v119
    ds_write_b64 v8, v[148:149] offset:768
    ds_write_b64 v8, v[150:151] offset:896
    s_waitcnt lgkmcnt(0)
    v_xor_b32 v13, 0, v10
    v_lshl_add_u32 v96, v13, 4, v11
    ds_read_b128 v[16:19], v96 offset:0
    v_xor_b32 v13, 2, v10
    v_lshl_add_u32 v97, v13, 4, v11
    ds_read_b128 v[20:23], v97 offset:1024
    v_xor_b32 v13, 4, v10
    v_lshl_add_u32 v98, v13, 4, v11
    ds_read_b128 v[24:27], v98 offset:2048
    v_xor_b32 v13, 6, v10
    v_lshl_add_u32 v99, v13, 4, v11
    ds_read_b128 v[28:31], v99 offset:3072
    s_mov_b32 s6, s84
    s_mov_b32 s59, s85
    s_cmp_eq_u32 s59, s7
    s_cselect_b32 s59, 0, 8
    s_cselect_b32 s12, 1, 0
    s_cmp_eq_u32 s6, 0
    s_cselect_b32 s12, 0, s12
    v_add_u32 v13, 0x10000, v12
    s_mov_b32 s76, 0
    s_mov_b32 s77, 32768
    s_waitcnt lgkmcnt(0)
    s_cmp_eq_u32 s12, 1
    s_cbranch_scc1 Lf_1
    buffer_store_dwordx4 v[16:19], v12, s[8:11], s76 offen sc1
    buffer_store_dwordx4 v[20:23], v12, s[8:11], s77 offen sc1
    s_branch Lg_2
Lf_1:
    buffer_store_dwordx4 v[16:19], v12, s[8:11], s76 offen
    buffer_store_dwordx4 v[20:23], v12, s[8:11], s77 offen
Lg_2:
    s_cmp_eq_u32 s3, 2
    s_cbranch_scc1 L_akv
    s_cmp_eq_u32 s12, 1
    s_cbranch_scc1 Lf_3
    buffer_store_dwordx4 v[24:27], v13, s[8:11], s76 offen sc1
    buffer_store_dwordx4 v[28:31], v13, s[8:11], s77 offen sc1
    s_branch Lg_4
Lf_3:
    buffer_store_dwordx4 v[24:27], v13, s[8:11], s76 offen
    buffer_store_dwordx4 v[28:31], v13, s[8:11], s77 offen
Lg_4:
L_akv:
    s_add_u32 m0, s69, 32
    s_lshl_b32 s70, s68, 12
    buffer_load_dwordx4 v7, s[60:63], s70 offen offset:0 lds
    buffer_load_dwordx4 v7, s[60:63], s70 offen offset:1024 lds
    buffer_load_dwordx4 v7, s[60:63], s70 offen offset:2048 lds
    buffer_load_dwordx4 v7, s[60:63], s70 offen offset:3072 lds
    v_mov_b32 v8, 0
    v_lshlrev_b32 v10, 2, v1
    v_add_u32 v10, s66, v10
    ds_write_b32 v10, v8
    v_mov_b32 v9, 0
    v_lshl_add_u32 v10, v1, 3, s66
    ds_write_b64 v10, v[8:9] offset:5632
    s_mov_b64 exec, 3
    ds_write_b64 v10, v[8:9] offset:4608
    s_mov_b64 exec, -1
    v_and_b32 v10, 3, v1
    v_bfe_u32 v11, v1, 2, 2
    v_lshrrev_b32 v12, 4, v1
    v_lshlrev_b32 v2, 5, v10
    v_lshl_add_u32 v2, v12, 6, v2
    v_lshl_add_u32 v2, v11, 3, v2
    s_add_u32 s71, s66, 32
    v_add_u32 v2, s71, v2
    v_sub_u32 v3, v10, v11
    v_lshlrev_b32 v3, 3, v3
    v_lshlrev_b32 v14, 6, v12
    v_sub_u32 v3, v3, v14
    s_add_u32 s71, s69, 224
    v_add_u32 v3, s71, v3
    v_lshl_add_u32 v4, v1, 2, s69
    v_lshl_add_u32 v5, v1, 2, s66
    v_mov_b32 v14, s69
    v_mov_b32 v15, s66
    v_and_b32 v8, 8, v1
    v_cmp_ne_u32 vcc, 0, v8
    v_and_b32 v8, 7, v1
    v_lshrrev_b32 v9, 3, v1
    v_cndmask_b32 v6, v14, v15, vcc
    v_lshl_add_u32 v6, v12, 8, v6
    v_lshl_add_u32 v6, v8, 5, v6
    s_add_u32 s71, s66, 6144
    v_lshl_add_u32 v10, v1, 4, s71
    s_add_u32 s71, s66, 4624
    v_writelane_b32 v10, s71, 63
    s_add_u32 s71, s66, 4608
    v_lshl_add_u32 v11, v9, 4, s71
    s_add_u32 s71, s66, 5632
    v_mov_b32 v14, s71
    v_cmp_eq_u32 vcc, 0, v8
    s_mov_b32 s71, 81920
    v_mul_lo_u32 v9, v9, s71
    v_cndmask_b32 v11, v14, v11, vcc
    v_lshl_add_u32 v9, v8, 4, v9
    s_lshl_b32 s71, s68, 7
    v_add_u32 v9, s71, v9
    s_lshl_b32 s65, s68, 12
    s_add_u32 m0, s66, 256
    s_add_u32 s70, s65, 0
    s_waitcnt vmcnt(4)
    v_mov_b32 v224, 160128
    v_mov_b32 v225, 1
    s_mov_b64 exec, 1
    ds_add_rtn_u32 v226, v224, v225
    s_mov_b64 exec, -1
    s_waitcnt lgkmcnt(0)
    v_readfirstlane_b32 s78, v226
    s_nop 0
    s_add_u32 s78, s78, 1
    s_cmp_lg_u32 s78, 3
    s_cbranch_scc1 Lnl_5
    s_cmp_lg_u32 s6, 0
    s_cbranch_scc1 L_tagok2
    v_and_b32 v228, 7, v1
    v_lshlrev_b32 v228, 3, v228
    s_mov_b32 s79, 0
Lpoll_6:
    buffer_load_dwordx2 v[14:15], v228, s[52:55], 0 offen sc1
    s_waitcnt vmcnt(0)
    v_cmp_eq_u32 vcc, 0, v14
    s_cbranch_vccz Lpd_7
    s_add_u32 s79, s79, 1
    s_cmp_lt_u32 s79, s80
    s_cbranch_scc1 Lpoll_6
    s_mov_b32 s80, 0
Lpd_7:
    v_readlane_b32 s6, v14, s4
    v_readlane_b32 s59, v15, s4
    s_nop 0
    s_cmp_eq_u32 s59, s7
    s_cselect_b32 s59, 0, 8
    s_cselect_b32 s12, 1, 0
    s_cmp_eq_u32 s6, 0
    s_cselect_b32 s12, 0, s12
L_tagok2:
    s_add_u32 s78, s6, 1
    s_add_u32 s78, s78, s59
    v_mov_b32 v12, s78
    v_mov_b32 v13, 0
    s_lshl_b32 s77, s4, 9
    s_lshl_b32 s76, s5, 2
    s_add_u32 s77, s77, s76
    s_add_u32 s77, s77, 0xec4000
    s_mov_b64 exec, 1
    s_cmp_eq_u32 s12, 1
    s_cbranch_scc1 Lf_8
    buffer_store_dword v12, v13, s[8:11], s77 offen sc1
    s_branch Lg_9
Lf_8:
    buffer_store_dword v12, v13, s[8:11], s77 offen
Lg_9:
    s_mov_b64 exec, -1
    s_cmp_eq_u32 s12, 0
    s_cbranch_scc1 L_s1slow
    v_and_b32 v12, 31, v1
    v_lshlrev_b32 v12, 2, v12
    s_lshl_b32 s77, s4, 9
    s_add_u32 s77, s77, 0xec4000
    buffer_load_dword v240, v12, s[8:11], s77 offen sc1
    s_sleep 3
    buffer_load_dword v241, v12, s[8:11], s77 offen sc1
    s_sleep 3
    s_mov_b32 s79, 0
Lpp_10:
    buffer_load_dword v242, v12, s[8:11], s77 offen sc1
    s_waitcnt vmcnt(2)
    v_subrev_u32 v13, s6, v240
    v_and_b32 v14, -9, v13
    v_subrev_u32 v14, 1, v14
    v_cmp_le_u32 vcc, 6, v14
    s_cbranch_vccz Lpe_11
    buffer_load_dword v240, v12, s[8:11], s77 offen sc1
    s_waitcnt vmcnt(2)
    v_subrev_u32 v13, s6, v241
    v_and_b32 v14, -9, v13
    v_subrev_u32 v14, 1, v14
    v_cmp_le_u32 vcc, 6, v14
    s_cbranch_vccz Lpe_11
    buffer_load_dword v241, v12, s[8:11], s77 offen sc1
    s_waitcnt vmcnt(2)
    v_subrev_u32 v13, s6, v242
    v_and_b32 v14, -9, v13
    v_subrev_u32 v14, 1, v14
    v_cmp_le_u32 vcc, 6, v14
    s_cbranch_vccz Lpe_11
    s_add_u32 s79, s79, 1
    s_cmp_lt_u32 s79, s80
    s_cbranch_scc1 Lpp_10
    s_mov_b32 s80, 0
Lpe_11:
    v_and_b32 v13, 8, v13
    v_cmp_ne_u32 vcc, 0, v13
    s_cbranch_vccz L_s1ok
    buffer_wbl2 sc1
    s_waitcnt vmcnt(0)
    s_mov_b32 s12, 0
L_s1slow:
    s_add_u32 s78, s6, 1
    s_add_u32 s78, s78, s59
    v_mov_b32 v12, s78
    v_mov_b32 v13, 0
    s_lshl_b32 s77, s4, 9
    s_lshl_b32 s76, s5, 2
    s_add_u32 s77, s77, s76
    s_add_u32 s77, s77, 0xec4180
    s_mov_b64 exec, 1
    buffer_store_dword v12, v13, s[8:11], s77 offen sc1
    s_mov_b64 exec, -1
    v_min_u32 v12, 31, v1
    v_lshlrev_b32 v12, 2, v12
    s_lshl_b32 s77, s4, 9
    s_add_u32 s77, s77, 0xec4180
    s_mov_b32 s79, 0
Lpoll_12:
    buffer_load_dword v13, v12, s[8:11], s77 offen sc1
    s_waitcnt vmcnt(0)
    v_subrev_u32 v13, s6, v13
    v_and_b32 v14, -9, v13
    v_subrev_u32 v14, 1, v14
    v_cmp_le_u32 vcc, 6, v14
    s_cbranch_vccz Lpd_13
    s_add_u32 s79, s79, 1
    s_cmp_lt_u32 s79, s80
    s_cbranch_scc1 Lpoll_12
    s_mov_b32 s80, 0
Lpd_13:
L_s1ok:
    v_mov_b32 v12, 160136
    s_add_u32 s76, s12, 1
    v_mov_b32 v14, s76
    v_mov_b32 v15, s6
    ds_write_b64 v12, v[14:15]
Lnl_5:
    v_mov_b32 v224, 160136
    s_mov_b32 s79, 0
Llw_14:
    ds_read_b32 v225, v224
    s_waitcnt lgkmcnt(0)
    v_cmp_eq_u32 vcc, 0, v225
    s_cbranch_vccz Lld_15
    s_add_u32 s79, s79, 1
    s_lshr_b32 s81, s79, 3
    s_cmp_lt_u32 s81, s80
    s_cbranch_scc1 Llw_14
    s_mov_b32 s80, 0
Lld_15:
    v_readfirstlane_b32 s12, v225
    s_nop 0
    s_lshr_b32 s12, s12, 1
    ds_read_b32 v225, v224 offset:4
    s_waitcnt lgkmcnt(0)
    v_readfirstlane_b32 s6, v225
    s_lshl_b32 s59, s12, 3
    s_xor_b32 s59, s59, 8
    s_mov_b32 s94, s66
    s_cmp_lt_u32 s67, 80
    s_cbranch_scc1 L_conv
    v_mov_b32 v12, 160156
    v_mov_b32 v13, 1
    ds_write_b32 v12, v13
    s_cmp_lg_u32 s5, 31
    s_cbranch_scc1 L_nolead
    s_cmp_lg_u32 s3, 2
    s_cbranch_scc1 L_nolead
    v_min_u32 v10, 31, v1
    v_lshlrev_b32 v10, 2, v10
    s_lshl_b32 s77, s4, 9
    s_add_u32 s77, s77, 0xec5080
    s_mov_b32 s79, 0
Lpoll_16:
    buffer_load_dword v11, v10, s[8:11], s77 offen sc1
    s_waitcnt vmcnt(0)
    v_subrev_u32 v11, s6, v11
    v_and_b32 v12, -9, v11
    v_subrev_u32 v12, 2, v12
    v_cmp_le_u32 vcc, 6, v12
    s_cbranch_vccz Lpd_17
    s_add_u32 s79, s79, 1
    s_cmp_lt_u32 s79, s80
    s_cbranch_scc1 Lpoll_16
    s_mov_b32 s80, 0
Lpd_17:
    s_add_u32 s78, s6, 1
    v_mov_b32 v34, s78
    v_lshlrev_b32 v33, 9, v1
    s_lshl_b32 s77, s4, 2
    s_add_u32 s77, s77, 0xec4140
    s_mov_b64 exec, 0xff
    buffer_store_dword v34, v33, s[8:11], s77 offen sc1
    s_mov_b64 exec, -1
L_nolead:
    s_cmp_lg_u32 s3, 2
    s_cbranch_scc1 L_nol2
    s_mov_b32 s79, 0
Lpoll_18:
    s_sleep 4
    v_and_b32 v10, 7, v1
    v_lshlrev_b32 v12, 3, v10
    v_lshlrev_b32 v10, 2, v10
    s_lshl_b32 s71, s4, 9
    s_add_u32 s71, s71, 0xec4140
    buffer_load_dword v12, v12, s[52:55], 0 offen sc1
    buffer_load_dword v11, v10, s[8:11], s71 offen sc1
    s_waitcnt vmcnt(0)
    v_sub_u32 v11, v11, v12
    v_cmp_ne_u32 vcc, 1, v11
    s_cbranch_vccz Lpd_19
    s_add_u32 s79, s79, 1
    s_cmp_lt_u32 s79, s80
    s_cbranch_scc1 Lpoll_18
    s_mov_b32 s80, 0
Lpd_19:
    v_mov_b32 v12, 160144
    v_mov_b32 v13, 1
    ds_write_b32 v12, v13
L_nol2:
    v_mov_b32 v224, 160144
    s_mov_b32 s79, 0
Llw_20:
    ds_read_b32 v225, v224
    s_waitcnt lgkmcnt(0)
    v_cmp_eq_u32 vcc, 0, v225
    s_cbranch_vccz Lld_21
    s_add_u32 s79, s79, 1
    s_lshr_b32 s81, s79, 3
    s_cmp_lt_u32 s81, s80
    s_cbranch_scc1 Llw_20
    s_mov_b32 s80, 0
Lld_21:
    s_branch L_pre
L_conv:
    buffer_load_dwordx4 v7, s[8:11], s70 offen offset:0 sc1 lds
    buffer_load_dwordx4 v7, s[8:11], s70 offen offset:1024 sc1 lds
    buffer_load_dwordx4 v7, s[8:11], s70 offen offset:2048 sc1 lds
    buffer_load_dwordx4 v7, s[8:11], s70 offen offset:3072 sc1 lds
    ds_read_b64_tr_b16 v[144:145], v3 offset:32
    ds_read_b64_tr_b16 v[146:147], v3 offset:0
    ds_read_b64_tr_b16 v[148:149], v3 offset:288
    ds_read_b64_tr_b16 v[150:151], v3 offset:256
    ds_read_b64_tr_b16 v[152:153], v3 offset:544
    ds_read_b64_tr_b16 v[154:155], v3 offset:512
    ds_read_b64_tr_b16 v[156:157], v3 offset:800
    ds_read_b64_tr_b16 v[158:159], v3 offset:768
    v_lshl_add_u32 v14, v1, 4, s66
    s_waitcnt vmcnt(3)
    ds_read_b64_tr_b16 v[16:17], v2 offset:0
    ds_read_b64_tr_b16 v[18:19], v2 offset:32
    ds_read_b64_tr_b16 v[20:21], v2 offset:128
    ds_read_b64_tr_b16 v[22:23], v2 offset:160
    ds_read_b64_tr_b16 v[24:25], v2 offset:256
    ds_read_b64_tr_b16 v[26:27], v2 offset:288
    ds_read_b64_tr_b16 v[28:29], v2 offset:384
    ds_read_b64_tr_b16 v[30:31], v2 offset:416
    ds_read_b64_tr_b16 v[32:33], v2 offset:512
    ds_read_b64_tr_b16 v[34:35], v2 offset:544
    ds_read_b64_tr_b16 v[36:37], v2 offset:640
    ds_read_b64_tr_b16 v[38:39], v2 offset:672
    s_waitcnt vmcnt(0)
    ds_read_b64_tr_b16 v[40:41], v2 offset:768
    ds_read_b64_tr_b16 v[42:43], v2 offset:800
    ds_read_b64_tr_b16 v[44:45], v2 offset:896
    ds_read_b64_tr_b16 v[46:47], v2 offset:928
    ds_read_b128 v[232:235], v14 offset:256
    ds_read_b128 v[236:239], v14 offset:1280
    ds_read_b128 v[240:243], v14 offset:2304
    ds_read_b128 v[244:247], v14 offset:3328
    v_mov_b32 v12, 160156
    v_mov_b32 v13, 1
    ds_write_b32 v12, v13
    s_waitcnt lgkmcnt(15)
    v_mfma_f32_16x16x32_bf16 v[208:211], v[16:19], v[144:147], 0
    ds_read_b64_tr_b16 v[160:161], v3 offset:1056
    ds_read_b64_tr_b16 v[162:163], v3 offset:1024
    ds_read_b64_tr_b16 v[48:49], v2 offset:1024
    v_mfma_f32_16x16x32_bf16 v[212:215], v[20:23], v[144:147], 0
    ds_read_b64_tr_b16 v[50:51], v2 offset:1056
    ds_read_b64_tr_b16 v[52:53], v2 offset:1152
    ds_read_b64_tr_b16 v[54:55], v2 offset:1184
    v_mfma_f32_16x16x32_bf16 v[216:219], v[16:19], v[148:151], 0
    ds_read_b64_tr_b16 v[164:165], v3 offset:1312
    ds_read_b64_tr_b16 v[166:167], v3 offset:1280
    ds_read_b64_tr_b16 v[56:57], v2 offset:1280
    ds_read_b64_tr_b16 v[58:59], v2 offset:1312
    v_mfma_f32_16x16x32_bf16 v[220:223], v[20:23], v[148:151], 0
    ds_read_b64_tr_b16 v[60:61], v2 offset:1408
    ds_read_b64_tr_b16 v[62:63], v2 offset:1440
    v_add_f32_dpp v210, v211, v210 wave_shr:1 row_mask:0xf bank_mask:0xf bound_ctrl:0
    v_add_f32_dpp v214, v215, v214 wave_shr:1 row_mask:0xf bank_mask:0xf bound_ctrl:0
    s_waitcnt lgkmcnt(15)
    v_mfma_f32_16x16x32_bf16 v[216:219], v[24:27], v[144:147], v[216:219]
    v_add_f32_dpp v209, v210, v209 wave_shr:1 row_mask:0xf bank_mask:0xf bound_ctrl:0
    v_add_f32_dpp v213, v214, v213 wave_shr:1 row_mask:0xf bank_mask:0xf bound_ctrl:0
    s_nop 0
    v_add_f32_dpp v208, v209, v208 wave_shr:1 row_mask:0xf bank_mask:0xf bound_ctrl:0
    v_add_f32_dpp v212, v213, v212 wave_shr:1 row_mask:0xf bank_mask:0xf bound_ctrl:0
    v_mfma_f32_16x16x32_bf16 v[220:223], v[28:31], v[144:147], v[220:223]
    ds_write_b32 v4, v208 offset:0
    ds_write_b32 v5, v212 offset:0
    ds_write_b128 v10, v[208:211] offset:0
    ds_write_b128 v10, v[212:215] offset:16
    v_mfma_f32_16x16x32_bf16 v[208:211], v[24:27], v[148:151], 0
    ds_read_b64_tr_b16 v[168:169], v3 offset:1568
    ds_read_b64_tr_b16 v[170:171], v3 offset:1536
    v_mfma_f32_16x16x32_bf16 v[212:215], v[28:31], v[148:151], 0
    ds_read_b64_tr_b16 v[64:65], v2 offset:1536
    ds_read_b64_tr_b16 v[66:67], v2 offset:1568
    ds_read_b64_tr_b16 v[68:69], v2 offset:1664
    v_mfma_f32_16x16x32_bf16 v[208:211], v[16:19], v[152:155], v[208:211]
    ds_read_b64_tr_b16 v[70:71], v2 offset:1696
    v_add_f32_dpp v218, v219, v218 wave_shr:1 row_mask:0xf bank_mask:0xf bound_ctrl:0
    v_add_f32_dpp v222, v223, v222 wave_shr:1 row_mask:0xf bank_mask:0xf bound_ctrl:0
    v_mfma_f32_16x16x32_bf16 v[212:215], v[20:23], v[152:155], v[212:215]
    v_add_f32_dpp v217, v218, v217 wave_shr:1 row_mask:0xf bank_mask:0xf bound_ctrl:0
    v_add_f32_dpp v221, v222, v221 wave_shr:1 row_mask:0xf bank_mask:0xf bound_ctrl:0
    v_mfma_f32_16x16x32_bf16 v[208:211], v[32:35], v[144:147], v[208:211]
    v_add_f32_dpp v216, v217, v216 wave_shr:1 row_mask:0xf bank_mask:0xf bound_ctrl:0
    v_add_f32_dpp v220, v221, v220 wave_shr:1 row_mask:0xf bank_mask:0xf bound_ctrl:0
    ds_write_b32 v4, v216 offset:256
    v_mfma_f32_16x16x32_bf16 v[212:215], v[36:39], v[144:147], v[212:215]
    ds_write_b32 v5, v220 offset:256
    ds_write_b128 v10, v[216:219] offset:32
    ds_write_b128 v10, v[220:223] offset:48
    v_mfma_f32_16x16x32_bf16 v[216:219], v[24:27], v[152:155], 0
    ds_read_b64_tr_b16 v[172:173], v3 offset:1824
    ds_read_b64_tr_b16 v[174:175], v3 offset:1792
    v_mfma_f32_16x16x32_bf16 v[220:223], v[28:31], v[152:155], 0
    ds_read_b64_tr_b16 v[72:73], v2 offset:1792
    ds_read_b64_tr_b16 v[74:75], v2 offset:1824
    v_mfma_f32_16x16x32_bf16 v[216:219], v[32:35], v[148:151], v[216:219]
    ds_read_b64_tr_b16 v[76:77], v2 offset:1920
    ds_read_b64_tr_b16 v[78:79], v2 offset:1952
    v_mfma_f32_16x16x32_bf16 v[220:223], v[36:39], v[148:151], v[220:223]
    v_add_f32_dpp v210, v211, v210 wave_shr:1 row_mask:0xf bank_mask:0xf bound_ctrl:0
    v_add_f32_dpp v214, v215, v214 wave_shr:1 row_mask:0xf bank_mask:0xf bound_ctrl:0
    v_mfma_f32_16x16x32_bf16 v[216:219], v[16:19], v[156:159], v[216:219]
    v_add_f32_dpp v209, v210, v209 wave_shr:1 row_mask:0xf bank_mask:0xf bound_ctrl:0
    v_add_f32_dpp v213, v214, v213 wave_shr:1 row_mask:0xf bank_mask:0xf bound_ctrl:0
    v_mfma_f32_16x16x32_bf16 v[220:223], v[20:23], v[156:159], v[220:223]
    v_add_f32_dpp v208, v209, v208 wave_shr:1 row_mask:0xf bank_mask:0xf bound_ctrl:0
    v_add_f32_dpp v212, v213, v212 wave_shr:1 row_mask:0xf bank_mask:0xf bound_ctrl:0
    v_mfma_f32_16x16x32_bf16 v[216:219], v[40:43], v[144:147], v[216:219]
    ds_write_b32 v4, v208 offset:512
    ds_write_b32 v5, v212 offset:512
    v_mfma_f32_16x16x32_bf16 v[220:223], v[44:47], v[144:147], v[220:223]
    ds_write_b128 v10, v[208:211] offset:64
    ds_write_b128 v10, v[212:215] offset:80
    v_mfma_f32_16x16x32_bf16 v[208:211], v[24:27], v[156:159], 0
    ds_read_b64_tr_b16 v[176:177], v3 offset:2080
    v_mfma_f32_16x16x32_bf16 v[212:215], v[28:31], v[156:159], 0
    ds_read_b64_tr_b16 v[178:179], v3 offset:2048
    ds_read_b64_tr_b16 v[80:81], v2 offset:2048
    v_mfma_f32_16x16x32_bf16 v[208:211], v[32:35], v[152:155], v[208:211]
    ds_read_b64_tr_b16 v[82:83], v2 offset:2080
    v_mfma_f32_16x16x32_bf16 v[212:215], v[36:39], v[152:155], v[212:215]
    ds_read_b64_tr_b16 v[84:85], v2 offset:2176
    ds_read_b64_tr_b16 v[86:87], v2 offset:2208
    v_mfma_f32_16x16x32_bf16 v[208:211], v[40:43], v[148:151], v[208:211]
    v_add_f32_dpp v218, v219, v218 wave_shr:1 row_mask:0xf bank_mask:0xf bound_ctrl:0
    v_add_f32_dpp v222, v223, v222 wave_shr:1 row_mask:0xf bank_mask:0xf bound_ctrl:0
    v_mfma_f32_16x16x32_bf16 v[212:215], v[44:47], v[148:151], v[212:215]
    v_add_f32_dpp v217, v218, v217 wave_shr:1 row_mask:0xf bank_mask:0xf bound_ctrl:0
    s_waitcnt lgkmcnt(15)
    v_mfma_f32_16x16x32_bf16 v[208:211], v[16:19], v[160:163], v[208:211]
    v_add_f32_dpp v221, v222, v221 wave_shr:1 row_mask:0xf bank_mask:0xf bound_ctrl:0
    v_add_f32_dpp v216, v217, v216 wave_shr:1 row_mask:0xf bank_mask:0xf bound_ctrl:0
    v_mfma_f32_16x16x32_bf16 v[212:215], v[20:23], v[160:163], v[212:215]
    v_add_f32_dpp v220, v221, v220 wave_shr:1 row_mask:0xf bank_mask:0xf bound_ctrl:0
    v_mfma_f32_16x16x32_bf16 v[208:211], v[48:51], v[144:147], v[208:211]
    ds_write_b32 v4, v216 offset:768
    ds_write_b32 v5, v220 offset:768
    v_mfma_f32_16x16x32_bf16 v[212:215], v[52:55], v[144:147], v[212:215]
    ds_write_b128 v10, v[216:219] offset:96
    ds_write_b128 v10, v[220:223] offset:112
    v_mfma_f32_16x16x32_bf16 v[216:219], v[24:27], v[160:163], 0
    ds_read_b64_tr_b16 v[180:181], v3 offset:2336
    v_mfma_f32_16x16x32_bf16 v[220:223], v[28:31], v[160:163], 0
    ds_read_b64_tr_b16 v[182:183], v3 offset:2304
    v_mfma_f32_16x16x32_bf16 v[216:219], v[32:35], v[156:159], v[216:219]
    ds_read_b64_tr_b16 v[88:89], v2 offset:2304
    ds_read_b64_tr_b16 v[90:91], v2 offset:2336
    v_mfma_f32_16x16x32_bf16 v[220:223], v[36:39], v[156:159], v[220:223]
    ds_read_b64_tr_b16 v[92:93], v2 offset:2432
    v_mfma_f32_16x16x32_bf16 v[216:219], v[40:43], v[152:155], v[216:219]
    ds_read_b64_tr_b16 v[94:95], v2 offset:2464
    v_mfma_f32_16x16x32_bf16 v[220:223], v[44:47], v[152:155], v[220:223]
    v_add_f32_dpp v210, v211, v210 wave_shr:1 row_mask:0xf bank_mask:0xf bound_ctrl:0
    v_add_f32_dpp v214, v215, v214 wave_shr:1 row_mask:0xf bank_mask:0xf bound_ctrl:0
    v_mfma_f32_16x16x32_bf16 v[216:219], v[48:51], v[148:151], v[216:219]
    v_add_f32_dpp v209, v210, v209 wave_shr:1 row_mask:0xf bank_mask:0xf bound_ctrl:0
    v_mfma_f32_16x16x32_bf16 v[220:223], v[52:55], v[148:151], v[220:223]
    v_add_f32_dpp v213, v214, v213 wave_shr:1 row_mask:0xf bank_mask:0xf bound_ctrl:0
    v_mfma_f32_16x16x32_bf16 v[216:219], v[16:19], v[164:167], v[216:219]
    v_add_f32_dpp v208, v209, v208 wave_shr:1 row_mask:0xf bank_mask:0xf bound_ctrl:0
    v_add_f32_dpp v212, v213, v212 wave_shr:1 row_mask:0xf bank_mask:0xf bound_ctrl:0
    v_mfma_f32_16x16x32_bf16 v[220:223], v[20:23], v[164:167], v[220:223]
    ds_write_b32 v4, v208 offset:1024
    v_mfma_f32_16x16x32_bf16 v[216:219], v[56:59], v[144:147], v[216:219]
    ds_write_b32 v5, v212 offset:1024
    v_mfma_f32_16x16x32_bf16 v[220:223], v[60:63], v[144:147], v[220:223]
    ds_write_b128 v10, v[208:211] offset:128
    ds_write_b128 v10, v[212:215] offset:144
    v_mfma_f32_16x16x32_bf16 v[208:211], v[24:27], v[164:167], 0
    ds_read_b64_tr_b16 v[184:185], v3 offset:2592
    ds_read_b64_tr_b16 v[186:187], v3 offset:2560
    ds_read_b64_tr_b16 v[96:97], v2 offset:2560
    v_mfma_f32_16x16x32_bf16 v[212:215], v[28:31], v[164:167], 0
    ds_read_b64_tr_b16 v[98:99], v2 offset:2592
    ds_read_b64_tr_b16 v[100:101], v2 offset:2688
    ds_read_b64_tr_b16 v[102:103], v2 offset:2720
    v_mfma_f32_16x16x32_bf16 v[208:211], v[32:35], v[160:163], v[208:211]
    v_add_f32_dpp v218, v219, v218 wave_shr:1 row_mask:0xf bank_mask:0xf bound_ctrl:0
    v_add_f32_dpp v222, v223, v222 wave_shr:1 row_mask:0xf bank_mask:0xf bound_ctrl:0
    s_nop 0
    v_add_f32_dpp v217, v218, v217 wave_shr:1 row_mask:0xf bank_mask:0xf bound_ctrl:0
    v_mfma_f32_16x16x32_bf16 v[212:215], v[36:39], v[160:163], v[212:215]
    v_add_f32_dpp v221, v222, v221 wave_shr:1 row_mask:0xf bank_mask:0xf bound_ctrl:0
    v_add_f32_dpp v216, v217, v216 wave_shr:1 row_mask:0xf bank_mask:0xf bound_ctrl:0
    s_nop 0
    v_add_f32_dpp v220, v221, v220 wave_shr:1 row_mask:0xf bank_mask:0xf bound_ctrl:0
    v_mfma_f32_16x16x32_bf16 v[208:211], v[40:43], v[156:159], v[208:211]
    ds_write_b32 v4, v216 offset:1280
    ds_write_b32 v5, v220 offset:1280
    ds_write_b128 v10, v[216:219] offset:160
    v_mfma_f32_16x16x32_bf16 v[212:215], v[44:47], v[156:159], v[212:215]
    ds_write_b128 v10, v[220:223] offset:176
    ds_read_b128 v[224:227], v6 offset:0
    ds_read_b128 v[228:231], v6 offset:16
    v_mfma_f32_16x16x32_bf16 v[208:211], v[48:51], v[152:155], v[208:211]
    ds_read_b128 v[248:251], v11 offset:0
    v_lshlrev_b32 v12, 16, v232
    v_and_b32 v13, s64, v232
    v_mfma_f32_16x16x32_bf16 v[212:215], v[52:55], v[152:155], v[212:215]
    s_waitcnt lgkmcnt(0)
    v_add_f32 v224, v224, v249
    v_add_f32 v225, v225, v250
    v_add_f32 v226, v226, v251
    v_mfma_f32_16x16x32_bf16 v[208:211], v[56:59], v[148:151], v[208:211]
    v_fmac_f32 v224, s72, v12
    v_fmac_f32 v225, s72, v13
    v_cvt_pk_bf16_f32 v232, v224, v225
    v_mfma_f32_16x16x32_bf16 v[212:215], v[60:63], v[148:151], v[212:215]
    v_lshlrev_b32 v14, 16, v233
    v_and_b32 v15, s64, v233
    v_fmac_f32 v226, s72, v14
    v_mfma_f32_16x16x32_bf16 v[208:211], v[16:19], v[168:171], v[208:211]
    v_fmac_f32 v227, s72, v15
    v_cvt_pk_bf16_f32 v233, v226, v227
    v_lshlrev_b32 v12, 16, v234
    v_mfma_f32_16x16x32_bf16 v[212:215], v[20:23], v[168:171], v[212:215]
    v_and_b32 v13, s64, v234
    v_fmac_f32 v228, s72, v12
    v_fmac_f32 v229, s72, v13
    v_mfma_f32_16x16x32_bf16 v[208:211], v[64:67], v[144:147], v[208:211]
    v_cvt_pk_bf16_f32 v234, v228, v229
    v_lshlrev_b32 v14, 16, v235
    v_and_b32 v15, s64, v235
    v_mfma_f32_16x16x32_bf16 v[212:215], v[68:71], v[144:147], v[212:215]
    v_fmac_f32 v230, s72, v14
    v_fmac_f32 v231, s72, v15
    v_cvt_pk_bf16_f32 v235, v230, v231
    v_mfma_f32_16x16x32_bf16 v[216:219], v[24:27], v[168:171], 0
    ds_read_b64_tr_b16 v[188:189], v3 offset:2848
    v_mfma_f32_16x16x32_bf16 v[220:223], v[28:31], v[168:171], 0
    ds_read_b64_tr_b16 v[190:191], v3 offset:2816
    v_mfma_f32_16x16x32_bf16 v[216:219], v[32:35], v[164:167], v[216:219]
    ds_read_b64_tr_b16 v[104:105], v2 offset:2816
    v_mfma_f32_16x16x32_bf16 v[220:223], v[36:39], v[164:167], v[220:223]
    ds_read_b64_tr_b16 v[106:107], v2 offset:2848
    v_mfma_f32_16x16x32_bf16 v[216:219], v[40:43], v[160:163], v[216:219]
    ds_read_b64_tr_b16 v[108:109], v2 offset:2944
    v_mfma_f32_16x16x32_bf16 v[220:223], v[44:47], v[160:163], v[220:223]
    ds_read_b64_tr_b16 v[110:111], v2 offset:2976
    v_mfma_f32_16x16x32_bf16 v[216:219], v[48:51], v[156:159], v[216:219]
    v_add_f32_dpp v210, v211, v210 wave_shr:1 row_mask:0xf bank_mask:0xf bound_ctrl:0
    v_mfma_f32_16x16x32_bf16 v[220:223], v[52:55], v[156:159], v[220:223]
    v_add_f32_dpp v214, v215, v214 wave_shr:1 row_mask:0xf bank_mask:0xf bound_ctrl:0
    v_mfma_f32_16x16x32_bf16 v[216:219], v[56:59], v[152:155], v[216:219]
    v_add_f32_dpp v209, v210, v209 wave_shr:1 row_mask:0xf bank_mask:0xf bound_ctrl:0
    v_mfma_f32_16x16x32_bf16 v[220:223], v[60:63], v[152:155], v[220:223]
    v_add_f32_dpp v213, v214, v213 wave_shr:1 row_mask:0xf bank_mask:0xf bound_ctrl:0
    v_mfma_f32_16x16x32_bf16 v[216:219], v[64:67], v[148:151], v[216:219]
    v_add_f32_dpp v208, v209, v208 wave_shr:1 row_mask:0xf bank_mask:0xf bound_ctrl:0
    v_mfma_f32_16x16x32_bf16 v[220:223], v[68:71], v[148:151], v[220:223]
    v_add_f32_dpp v212, v213, v212 wave_shr:1 row_mask:0xf bank_mask:0xf bound_ctrl:0
    v_mfma_f32_16x16x32_bf16 v[216:219], v[16:19], v[172:175], v[216:219]
    ds_write_b32 v4, v208 offset:1536
    v_mfma_f32_16x16x32_bf16 v[220:223], v[20:23], v[172:175], v[220:223]
    ds_write_b32 v5, v212 offset:1536
    v_mfma_f32_16x16x32_bf16 v[216:219], v[72:75], v[144:147], v[216:219]
    ds_write_b128 v10, v[208:211] offset:192
    v_mfma_f32_16x16x32_bf16 v[220:223], v[76:79], v[144:147], v[220:223]
    ds_write_b128 v10, v[212:215] offset:208
    v_mfma_f32_16x16x32_bf16 v[208:211], v[24:27], v[172:175], 0
    v_mfma_f32_16x16x32_bf16 v[212:215], v[28:31], v[172:175], 0
    ds_read_b64_tr_b16 v[192:193], v3 offset:3104
    v_mfma_f32_16x16x32_bf16 v[208:211], v[32:35], v[168:171], v[208:211]
    ds_read_b64_tr_b16 v[194:195], v3 offset:3072
    v_mfma_f32_16x16x32_bf16 v[212:215], v[36:39], v[168:171], v[212:215]
    ds_read_b64_tr_b16 v[112:113], v2 offset:3072
    v_mfma_f32_16x16x32_bf16 v[208:211], v[40:43], v[164:167], v[208:211]
    ds_read_b64_tr_b16 v[114:115], v2 offset:3104
    v_mfma_f32_16x16x32_bf16 v[212:215], v[44:47], v[164:167], v[212:215]
    ds_read_b64_tr_b16 v[116:117], v2 offset:3200
    v_mfma_f32_16x16x32_bf16 v[208:211], v[48:51], v[160:163], v[208:211]
    ds_read_b64_tr_b16 v[118:119], v2 offset:3232
    v_mfma_f32_16x16x32_bf16 v[212:215], v[52:55], v[160:163], v[212:215]
    v_add_f32_dpp v218, v219, v218 wave_shr:1 row_mask:0xf bank_mask:0xf bound_ctrl:0
    v_mfma_f32_16x16x32_bf16 v[208:211], v[56:59], v[156:159], v[208:211]
    v_add_f32_dpp v222, v223, v222 wave_shr:1 row_mask:0xf bank_mask:0xf bound_ctrl:0
    v_mfma_f32_16x16x32_bf16 v[212:215], v[60:63], v[156:159], v[212:215]
    v_mfma_f32_16x16x32_bf16 v[208:211], v[64:67], v[152:155], v[208:211]
    v_add_f32_dpp v217, v218, v217 wave_shr:1 row_mask:0xf bank_mask:0xf bound_ctrl:0
    v_mfma_f32_16x16x32_bf16 v[212:215], v[68:71], v[152:155], v[212:215]
    v_add_f32_dpp v221, v222, v221 wave_shr:1 row_mask:0xf bank_mask:0xf bound_ctrl:0
    v_mfma_f32_16x16x32_bf16 v[208:211], v[72:75], v[148:151], v[208:211]
    v_add_f32_dpp v216, v217, v216 wave_shr:1 row_mask:0xf bank_mask:0xf bound_ctrl:0
    v_mfma_f32_16x16x32_bf16 v[212:215], v[76:79], v[148:151], v[212:215]
    v_add_f32_dpp v220, v221, v220 wave_shr:1 row_mask:0xf bank_mask:0xf bound_ctrl:0
    v_mfma_f32_16x16x32_bf16 v[208:211], v[16:19], v[176:179], v[208:211]
    ds_write_b32 v4, v216 offset:1792
    v_mfma_f32_16x16x32_bf16 v[212:215], v[20:23], v[176:179], v[212:215]
    ds_write_b32 v5, v220 offset:1792
    v_mfma_f32_16x16x32_bf16 v[208:211], v[80:83], v[144:147], v[208:211]
    ds_write_b128 v10, v[216:219] offset:224
    v_mfma_f32_16x16x32_bf16 v[212:215], v[84:87], v[144:147], v[212:215]
    ds_write_b128 v10, v[220:223] offset:240
    v_mfma_f32_16x16x32_bf16 v[216:219], v[24:27], v[176:179], 0
    v_mfma_f32_16x16x32_bf16 v[220:223], v[28:31], v[176:179], 0
    ds_read_b64_tr_b16 v[196:197], v3 offset:3360
    v_mfma_f32_16x16x32_bf16 v[216:219], v[32:35], v[172:175], v[216:219]
    ds_read_b64_tr_b16 v[198:199], v3 offset:3328
    v_mfma_f32_16x16x32_bf16 v[220:223], v[36:39], v[172:175], v[220:223]
    ds_read_b64_tr_b16 v[120:121], v2 offset:3328
    v_mfma_f32_16x16x32_bf16 v[216:219], v[40:43], v[168:171], v[216:219]
    ds_read_b64_tr_b16 v[122:123], v2 offset:3360
    v_mfma_f32_16x16x32_bf16 v[220:223], v[44:47], v[168:171], v[220:223]
    v_mfma_f32_16x16x32_bf16 v[216:219], v[48:51], v[164:167], v[216:219]
    ds_read_b64_tr_b16 v[124:125], v2 offset:3456
    v_mfma_f32_16x16x32_bf16 v[220:223], v[52:55], v[164:167], v[220:223]
    ds_read_b64_tr_b16 v[126:127], v2 offset:3488
    v_mfma_f32_16x16x32_bf16 v[216:219], v[56:59], v[160:163], v[216:219]
    v_add_f32_dpp v210, v211, v210 wave_shr:1 row_mask:0xf bank_mask:0xf bound_ctrl:0
    v_mfma_f32_16x16x32_bf16 v[220:223], v[60:63], v[160:163], v[220:223]
    v_add_f32_dpp v214, v215, v214 wave_shr:1 row_mask:0xf bank_mask:0xf bound_ctrl:0
    v_mfma_f32_16x16x32_bf16 v[216:219], v[64:67], v[156:159], v[216:219]
    v_mfma_f32_16x16x32_bf16 v[220:223], v[68:71], v[156:159], v[220:223]
    v_add_f32_dpp v209, v210, v209 wave_shr:1 row_mask:0xf bank_mask:0xf bound_ctrl:0
    v_mfma_f32_16x16x32_bf16 v[216:219], v[72:75], v[152:155], v[216:219]
    v_add_f32_dpp v213, v214, v213 wave_shr:1 row_mask:0xf bank_mask:0xf bound_ctrl:0
    v_mfma_f32_16x16x32_bf16 v[220:223], v[76:79], v[152:155], v[220:223]
    v_add_f32_dpp v208, v209, v208 wave_shr:1 row_mask:0xf bank_mask:0xf bound_ctrl:0
    v_mfma_f32_16x16x32_bf16 v[216:219], v[80:83], v[148:151], v[216:219]
    v_add_f32_dpp v212, v213, v212 wave_shr:1 row_mask:0xf bank_mask:0xf bound_ctrl:0
    v_mfma_f32_16x16x32_bf16 v[220:223], v[84:87], v[148:151], v[220:223]
    v_mfma_f32_16x16x32_bf16 v[216:219], v[16:19], v[180:183], v[216:219]
    ds_write_b32 v4, v208 offset:2048
    v_mfma_f32_16x16x32_bf16 v[220:223], v[20:23], v[180:183], v[220:223]
    ds_write_b32 v5, v212 offset:2048
    v_mfma_f32_16x16x32_bf16 v[216:219], v[88:91], v[144:147], v[216:219]
    ds_write_b128 v10, v[208:211] offset:256
    v_mfma_f32_16x16x32_bf16 v[220:223], v[92:95], v[144:147], v[220:223]
    ds_write_b128 v10, v[212:215] offset:272
    v_mfma_f32_16x16x32_bf16 v[208:211], v[24:27], v[180:183], 0
    ds_read_b64_tr_b16 v[200:201], v3 offset:3616
    v_mfma_f32_16x16x32_bf16 v[212:215], v[28:31], v[180:183], 0
    ds_read_b64_tr_b16 v[202:203], v3 offset:3584
    ds_read_b64_tr_b16 v[128:129], v2 offset:3584
    v_mfma_f32_16x16x32_bf16 v[208:211], v[32:35], v[176:179], v[208:211]
    ds_read_b64_tr_b16 v[130:131], v2 offset:3616
    ds_read_b64_tr_b16 v[132:133], v2 offset:3712
    v_mfma_f32_16x16x32_bf16 v[212:215], v[36:39], v[176:179], v[212:215]
    ds_read_b64_tr_b16 v[134:135], v2 offset:3744
    v_add_f32_dpp v218, v219, v218 wave_shr:1 row_mask:0xf bank_mask:0xf bound_ctrl:0
    v_mfma_f32_16x16x32_bf16 v[208:211], v[40:43], v[172:175], v[208:211]
    v_add_f32_dpp v222, v223, v222 wave_shr:1 row_mask:0xf bank_mask:0xf bound_ctrl:0
    v_add_f32_dpp v217, v218, v217 wave_shr:1 row_mask:0xf bank_mask:0xf bound_ctrl:0
    v_mfma_f32_16x16x32_bf16 v[212:215], v[44:47], v[172:175], v[212:215]
    v_add_f32_dpp v221, v222, v221 wave_shr:1 row_mask:0xf bank_mask:0xf bound_ctrl:0
    v_add_f32_dpp v216, v217, v216 wave_shr:1 row_mask:0xf bank_mask:0xf bound_ctrl:0
    v_mfma_f32_16x16x32_bf16 v[208:211], v[48:51], v[168:171], v[208:211]
    v_add_f32_dpp v220, v221, v220 wave_shr:1 row_mask:0xf bank_mask:0xf bound_ctrl:0
    ds_write_b32 v4, v216 offset:2304
    v_mfma_f32_16x16x32_bf16 v[212:215], v[52:55], v[168:171], v[212:215]
    ds_write_b32 v5, v220 offset:2304
    ds_write_b128 v10, v[216:219] offset:288
    v_mfma_f32_16x16x32_bf16 v[208:211], v[56:59], v[164:167], v[208:211]
    ds_write_b128 v10, v[220:223] offset:304
    ds_read_b128 v[224:227], v6 offset:1024
    v_mfma_f32_16x16x32_bf16 v[212:215], v[60:63], v[164:167], v[212:215]
    ds_read_b128 v[228:231], v6 offset:1040
    ds_read_b128 v[248:251], v11 offset:128
    v_mfma_f32_16x16x32_bf16 v[208:211], v[64:67], v[160:163], v[208:211]
    v_lshlrev_b32 v12, 16, v236
    v_and_b32 v13, s64, v236
    v_mfma_f32_16x16x32_bf16 v[212:215], v[68:71], v[160:163], v[212:215]
    s_waitcnt lgkmcnt(0)
    v_add_f32 v224, v224, v249
    v_mfma_f32_16x16x32_bf16 v[208:211], v[72:75], v[156:159], v[208:211]
    v_add_f32 v225, v225, v250
    v_add_f32 v226, v226, v251
    v_mfma_f32_16x16x32_bf16 v[212:215], v[76:79], v[156:159], v[212:215]
    v_fmac_f32 v224, s72, v12
    v_fmac_f32 v225, s72, v13
    v_mfma_f32_16x16x32_bf16 v[208:211], v[80:83], v[152:155], v[208:211]
    v_cvt_pk_bf16_f32 v236, v224, v225
    v_lshlrev_b32 v14, 16, v237
    v_mfma_f32_16x16x32_bf16 v[212:215], v[84:87], v[152:155], v[212:215]
    v_and_b32 v15, s64, v237
    v_fmac_f32 v226, s72, v14
    v_mfma_f32_16x16x32_bf16 v[208:211], v[88:91], v[148:151], v[208:211]
    v_fmac_f32 v227, s72, v15
    v_cvt_pk_bf16_f32 v237, v226, v227
    v_mfma_f32_16x16x32_bf16 v[212:215], v[92:95], v[148:151], v[212:215]
    v_lshlrev_b32 v12, 16, v238
    v_and_b32 v13, s64, v238
    v_mfma_f32_16x16x32_bf16 v[208:211], v[16:19], v[184:187], v[208:211]
    v_fmac_f32 v228, s72, v12
    v_fmac_f32 v229, s72, v13
    v_mfma_f32_16x16x32_bf16 v[212:215], v[20:23], v[184:187], v[212:215]
    v_cvt_pk_bf16_f32 v238, v228, v229
    v_lshlrev_b32 v14, 16, v239
    v_mfma_f32_16x16x32_bf16 v[208:211], v[96:99], v[144:147], v[208:211]
    v_and_b32 v15, s64, v239
    v_fmac_f32 v230, s72, v14
    v_mfma_f32_16x16x32_bf16 v[212:215], v[100:103], v[144:147], v[212:215]
    v_fmac_f32 v231, s72, v15
    v_cvt_pk_bf16_f32 v239, v230, v231
    v_mfma_f32_16x16x32_bf16 v[216:219], v[24:27], v[184:187], 0
    v_mfma_f32_16x16x32_bf16 v[220:223], v[28:31], v[184:187], 0
    ds_read_b64_tr_b16 v[204:205], v3 offset:3872
    v_mfma_f32_16x16x32_bf16 v[216:219], v[32:35], v[180:183], v[216:219]
    ds_read_b64_tr_b16 v[206:207], v3 offset:3840
    v_mfma_f32_16x16x32_bf16 v[220:223], v[36:39], v[180:183], v[220:223]
    v_mfma_f32_16x16x32_bf16 v[216:219], v[40:43], v[176:179], v[216:219]
    ds_read_b64_tr_b16 v[136:137], v2 offset:3840
    v_mfma_f32_16x16x32_bf16 v[220:223], v[44:47], v[176:179], v[220:223]
    ds_read_b64_tr_b16 v[138:139], v2 offset:3872
    v_mfma_f32_16x16x32_bf16 v[216:219], v[48:51], v[172:175], v[216:219]
    v_mfma_f32_16x16x32_bf16 v[220:223], v[52:55], v[172:175], v[220:223]
    ds_read_b64_tr_b16 v[140:141], v2 offset:3968
    v_mfma_f32_16x16x32_bf16 v[216:219], v[56:59], v[168:171], v[216:219]
    ds_read_b64_tr_b16 v[142:143], v2 offset:4000
    v_mfma_f32_16x16x32_bf16 v[220:223], v[60:63], v[168:171], v[220:223]
    v_mfma_f32_16x16x32_bf16 v[216:219], v[64:67], v[164:167], v[216:219]
    v_add_f32_dpp v210, v211, v210 wave_shr:1 row_mask:0xf bank_mask:0xf bound_ctrl:0
    v_mfma_f32_16x16x32_bf16 v[220:223], v[68:71], v[164:167], v[220:223]
    v_add_f32_dpp v214, v215, v214 wave_shr:1 row_mask:0xf bank_mask:0xf bound_ctrl:0
    v_mfma_f32_16x16x32_bf16 v[216:219], v[72:75], v[160:163], v[216:219]
    v_mfma_f32_16x16x32_bf16 v[220:223], v[76:79], v[160:163], v[220:223]
    v_add_f32_dpp v209, v210, v209 wave_shr:1 row_mask:0xf bank_mask:0xf bound_ctrl:0
    v_mfma_f32_16x16x32_bf16 v[216:219], v[80:83], v[156:159], v[216:219]
    v_add_f32_dpp v213, v214, v213 wave_shr:1 row_mask:0xf bank_mask:0xf bound_ctrl:0
    v_mfma_f32_16x16x32_bf16 v[220:223], v[84:87], v[156:159], v[220:223]
    v_mfma_f32_16x16x32_bf16 v[216:219], v[88:91], v[152:155], v[216:219]
    v_add_f32_dpp v208, v209, v208 wave_shr:1 row_mask:0xf bank_mask:0xf bound_ctrl:0
    v_mfma_f32_16x16x32_bf16 v[220:223], v[92:95], v[152:155], v[220:223]
    v_add_f32_dpp v212, v213, v212 wave_shr:1 row_mask:0xf bank_mask:0xf bound_ctrl:0
    v_mfma_f32_16x16x32_bf16 v[216:219], v[96:99], v[148:151], v[216:219]
    v_mfma_f32_16x16x32_bf16 v[220:223], v[100:103], v[148:151], v[220:223]
    ds_write_b32 v4, v208 offset:2560
    v_mfma_f32_16x16x32_bf16 v[216:219], v[16:19], v[188:191], v[216:219]
    ds_write_b32 v5, v212 offset:2560
    v_mfma_f32_16x16x32_bf16 v[220:223], v[20:23], v[188:191], v[220:223]
    v_mfma_f32_16x16x32_bf16 v[216:219], v[104:107], v[144:147], v[216:219]
    ds_write_b128 v10, v[208:211] offset:320
    v_mfma_f32_16x16x32_bf16 v[220:223], v[108:111], v[144:147], v[220:223]
    ds_write_b128 v10, v[212:215] offset:336
    v_mfma_f32_16x16x32_bf16 v[208:211], v[24:27], v[188:191], 0
    v_mfma_f32_16x16x32_bf16 v[212:215], v[28:31], v[188:191], 0
    v_mfma_f32_16x16x32_bf16 v[208:211], v[32:35], v[184:187], v[208:211]
    v_mfma_f32_16x16x32_bf16 v[212:215], v[36:39], v[184:187], v[212:215]
    v_mfma_f32_16x16x32_bf16 v[208:211], v[40:43], v[180:183], v[208:211]
    v_mfma_f32_16x16x32_bf16 v[212:215], v[44:47], v[180:183], v[212:215]
    v_mfma_f32_16x16x32_bf16 v[208:211], v[48:51], v[176:179], v[208:211]
    v_add_f32_dpp v218, v219, v218 wave_shr:1 row_mask:0xf bank_mask:0xf bound_ctrl:0
    v_mfma_f32_16x16x32_bf16 v[212:215], v[52:55], v[176:179], v[212:215]
    v_mfma_f32_16x16x32_bf16 v[208:211], v[56:59], v[172:175], v[208:211]
    v_add_f32_dpp v222, v223, v222 wave_shr:1 row_mask:0xf bank_mask:0xf bound_ctrl:0
    v_mfma_f32_16x16x32_bf16 v[212:215], v[60:63], v[172:175], v[212:215]
    v_mfma_f32_16x16x32_bf16 v[208:211], v[64:67], v[168:171], v[208:211]
    v_add_f32_dpp v217, v218, v217 wave_shr:1 row_mask:0xf bank_mask:0xf bound_ctrl:0
    v_mfma_f32_16x16x32_bf16 v[212:215], v[68:71], v[168:171], v[212:215]
    v_mfma_f32_16x16x32_bf16 v[208:211], v[72:75], v[164:167], v[208:211]
    v_add_f32_dpp v221, v222, v221 wave_shr:1 row_mask:0xf bank_mask:0xf bound_ctrl:0
    v_mfma_f32_16x16x32_bf16 v[212:215], v[76:79], v[164:167], v[212:215]
    v_mfma_f32_16x16x32_bf16 v[208:211], v[80:83], v[160:163], v[208:211]
    v_add_f32_dpp v216, v217, v216 wave_shr:1 row_mask:0xf bank_mask:0xf bound_ctrl:0
    v_mfma_f32_16x16x32_bf16 v[212:215], v[84:87], v[160:163], v[212:215]
    v_mfma_f32_16x16x32_bf16 v[208:211], v[88:91], v[156:159], v[208:211]
    v_mfma_f32_16x16x32_bf16 v[212:215], v[92:95], v[156:159], v[212:215]
    v_add_f32_dpp v220, v221, v220 wave_shr:1 row_mask:0xf bank_mask:0xf bound_ctrl:0
    v_mfma_f32_16x16x32_bf16 v[208:211], v[96:99], v[152:155], v[208:211]
    v_mfma_f32_16x16x32_bf16 v[212:215], v[100:103], v[152:155], v[212:215]
    ds_write_b32 v4, v216 offset:2816
    v_mfma_f32_16x16x32_bf16 v[208:211], v[104:107], v[148:151], v[208:211]
    v_mfma_f32_16x16x32_bf16 v[212:215], v[108:111], v[148:151], v[212:215]
    ds_write_b32 v5, v220 offset:2816
    v_mfma_f32_16x16x32_bf16 v[208:211], v[16:19], v[192:195], v[208:211]
    v_mfma_f32_16x16x32_bf16 v[212:215], v[20:23], v[192:195], v[212:215]
    ds_write_b128 v10, v[216:219] offset:352
    v_mfma_f32_16x16x32_bf16 v[208:211], v[112:115], v[144:147], v[208:211]
    v_mfma_f32_16x16x32_bf16 v[212:215], v[116:119], v[144:147], v[212:215]
    ds_write_b128 v10, v[220:223] offset:368
    v_mfma_f32_16x16x32_bf16 v[216:219], v[24:27], v[192:195], 0
    v_mfma_f32_16x16x32_bf16 v[220:223], v[28:31], v[192:195], 0
    v_mfma_f32_16x16x32_bf16 v[216:219], v[32:35], v[188:191], v[216:219]
    v_mfma_f32_16x16x32_bf16 v[220:223], v[36:39], v[188:191], v[220:223]
    v_mfma_f32_16x16x32_bf16 v[216:219], v[40:43], v[184:187], v[216:219]
    s_nop 0
    v_add_f32_dpp v210, v211, v210 wave_shr:1 row_mask:0xf bank_mask:0xf bound_ctrl:0
    v_mfma_f32_16x16x32_bf16 v[220:223], v[44:47], v[184:187], v[220:223]
    v_add_f32_dpp v214, v215, v214 wave_shr:1 row_mask:0xf bank_mask:0xf bound_ctrl:0
    v_add_f32_dpp v209, v210, v209 wave_shr:1 row_mask:0xf bank_mask:0xf bound_ctrl:0
    v_mfma_f32_16x16x32_bf16 v[216:219], v[48:51], v[180:183], v[216:219]
    v_add_f32_dpp v213, v214, v213 wave_shr:1 row_mask:0xf bank_mask:0xf bound_ctrl:0
    v_mfma_f32_16x16x32_bf16 v[220:223], v[52:55], v[180:183], v[220:223]
    v_add_f32_dpp v208, v209, v208 wave_shr:1 row_mask:0xf bank_mask:0xf bound_ctrl:0
    v_add_f32_dpp v212, v213, v212 wave_shr:1 row_mask:0xf bank_mask:0xf bound_ctrl:0
    v_mfma_f32_16x16x32_bf16 v[216:219], v[56:59], v[176:179], v[216:219]
    ds_write_b32 v4, v208 offset:3072
    v_mfma_f32_16x16x32_bf16 v[220:223], v[60:63], v[176:179], v[220:223]
    ds_write_b32 v5, v212 offset:3072
    ds_write_b128 v10, v[208:211] offset:384
    v_mfma_f32_16x16x32_bf16 v[216:219], v[64:67], v[172:175], v[216:219]
    ds_write_b128 v10, v[212:215] offset:400
    v_mfma_f32_16x16x32_bf16 v[220:223], v[68:71], v[172:175], v[220:223]
    ds_read_b128 v[224:227], v6 offset:2048
    ds_read_b128 v[228:231], v6 offset:2064
    v_mfma_f32_16x16x32_bf16 v[216:219], v[72:75], v[168:171], v[216:219]
    ds_read_b128 v[248:251], v11 offset:256
    v_mfma_f32_16x16x32_bf16 v[220:223], v[76:79], v[168:171], v[220:223]
    v_lshlrev_b32 v12, 16, v240
    v_and_b32 v13, s64, v240
    v_mfma_f32_16x16x32_bf16 v[216:219], v[80:83], v[164:167], v[216:219]
    s_waitcnt lgkmcnt(0)
    v_add_f32 v224, v224, v249
    v_mfma_f32_16x16x32_bf16 v[220:223], v[84:87], v[164:167], v[220:223]
    v_add_f32 v225, v225, v250
    v_add_f32 v226, v226, v251
    v_mfma_f32_16x16x32_bf16 v[216:219], v[88:91], v[160:163], v[216:219]
    v_fmac_f32 v224, s72, v12
    v_mfma_f32_16x16x32_bf16 v[220:223], v[92:95], v[160:163], v[220:223]
    v_fmac_f32 v225, s72, v13
    v_cvt_pk_bf16_f32 v240, v224, v225
    v_mfma_f32_16x16x32_bf16 v[216:219], v[96:99], v[156:159], v[216:219]
    v_lshlrev_b32 v14, 16, v241
    v_mfma_f32_16x16x32_bf16 v[220:223], v[100:103], v[156:159], v[220:223]
    v_and_b32 v15, s64, v241
    v_fmac_f32 v226, s72, v14
    v_mfma_f32_16x16x32_bf16 v[216:219], v[104:107], v[152:155], v[216:219]
    v_fmac_f32 v227, s72, v15
    v_mfma_f32_16x16x32_bf16 v[220:223], v[108:111], v[152:155], v[220:223]
    v_cvt_pk_bf16_f32 v241, v226, v227
    v_lshlrev_b32 v12, 16, v242
    v_mfma_f32_16x16x32_bf16 v[216:219], v[112:115], v[148:151], v[216:219]
    v_and_b32 v13, s64, v242
    v_mfma_f32_16x16x32_bf16 v[220:223], v[116:119], v[148:151], v[220:223]
    v_fmac_f32 v228, s72, v12
    v_fmac_f32 v229, s72, v13
    v_mfma_f32_16x16x32_bf16 v[216:219], v[16:19], v[196:199], v[216:219]
    v_cvt_pk_bf16_f32 v242, v228, v229
    v_mfma_f32_16x16x32_bf16 v[220:223], v[20:23], v[196:199], v[220:223]
    v_lshlrev_b32 v14, 16, v243
    v_and_b32 v15, s64, v243
    v_mfma_f32_16x16x32_bf16 v[216:219], v[120:123], v[144:147], v[216:219]
    v_fmac_f32 v230, s72, v14
    v_mfma_f32_16x16x32_bf16 v[220:223], v[124:127], v[144:147], v[220:223]
    v_fmac_f32 v231, s72, v15
    v_cvt_pk_bf16_f32 v243, v230, v231
    v_mfma_f32_16x16x32_bf16 v[208:211], v[24:27], v[196:199], 0
    v_mfma_f32_16x16x32_bf16 v[212:215], v[28:31], v[196:199], 0
    v_mfma_f32_16x16x32_bf16 v[208:211], v[32:35], v[192:195], v[208:211]
    v_mfma_f32_16x16x32_bf16 v[212:215], v[36:39], v[192:195], v[212:215]
    v_mfma_f32_16x16x32_bf16 v[208:211], v[40:43], v[188:191], v[208:211]
    v_mfma_f32_16x16x32_bf16 v[212:215], v[44:47], v[188:191], v[212:215]
    v_mfma_f32_16x16x32_bf16 v[208:211], v[48:51], v[184:187], v[208:211]
    v_add_f32_dpp v218, v219, v218 wave_shr:1 row_mask:0xf bank_mask:0xf bound_ctrl:0
    v_mfma_f32_16x16x32_bf16 v[212:215], v[52:55], v[184:187], v[212:215]
    v_mfma_f32_16x16x32_bf16 v[208:211], v[56:59], v[180:183], v[208:211]
    v_mfma_f32_16x16x32_bf16 v[212:215], v[60:63], v[180:183], v[212:215]
    v_add_f32_dpp v222, v223, v222 wave_shr:1 row_mask:0xf bank_mask:0xf bound_ctrl:0
    v_mfma_f32_16x16x32_bf16 v[208:211], v[64:67], v[176:179], v[208:211]
    v_mfma_f32_16x16x32_bf16 v[212:215], v[68:71], v[176:179], v[212:215]
    v_add_f32_dpp v217, v218, v217 wave_shr:1 row_mask:0xf bank_mask:0xf bound_ctrl:0
    v_mfma_f32_16x16x32_bf16 v[208:211], v[72:75], v[172:175], v[208:211]
    v_mfma_f32_16x16x32_bf16 v[212:215], v[76:79], v[172:175], v[212:215]
    v_mfma_f32_16x16x32_bf16 v[208:211], v[80:83], v[168:171], v[208:211]
    v_add_f32_dpp v221, v222, v221 wave_shr:1 row_mask:0xf bank_mask:0xf bound_ctrl:0
    v_mfma_f32_16x16x32_bf16 v[212:215], v[84:87], v[168:171], v[212:215]
    v_mfma_f32_16x16x32_bf16 v[208:211], v[88:91], v[164:167], v[208:211]
    v_add_f32_dpp v216, v217, v216 wave_shr:1 row_mask:0xf bank_mask:0xf bound_ctrl:0
    v_mfma_f32_16x16x32_bf16 v[212:215], v[92:95], v[164:167], v[212:215]
    v_mfma_f32_16x16x32_bf16 v[208:211], v[96:99], v[160:163], v[208:211]
    v_mfma_f32_16x16x32_bf16 v[212:215], v[100:103], v[160:163], v[212:215]
    v_add_f32_dpp v220, v221, v220 wave_shr:1 row_mask:0xf bank_mask:0xf bound_ctrl:0
    v_mfma_f32_16x16x32_bf16 v[208:211], v[104:107], v[156:159], v[208:211]
    v_mfma_f32_16x16x32_bf16 v[212:215], v[108:111], v[156:159], v[212:215]
    v_mfma_f32_16x16x32_bf16 v[208:211], v[112:115], v[152:155], v[208:211]
    ds_write_b32 v4, v216 offset:3328
    v_mfma_f32_16x16x32_bf16 v[212:215], v[116:119], v[152:155], v[212:215]
    v_mfma_f32_16x16x32_bf16 v[208:211], v[120:123], v[148:151], v[208:211]
    ds_write_b32 v5, v220 offset:3328
    v_mfma_f32_16x16x32_bf16 v[212:215], v[124:127], v[148:151], v[212:215]
    v_mfma_f32_16x16x32_bf16 v[208:211], v[16:19], v[200:203], v[208:211]
    v_mfma_f32_16x16x32_bf16 v[212:215], v[20:23], v[200:203], v[212:215]
    ds_write_b128 v10, v[216:219] offset:416
    v_mfma_f32_16x16x32_bf16 v[208:211], v[128:131], v[144:147], v[208:211]
    v_mfma_f32_16x16x32_bf16 v[212:215], v[132:135], v[144:147], v[212:215]
    ds_write_b128 v10, v[220:223] offset:432
    v_mfma_f32_16x16x32_bf16 v[216:219], v[24:27], v[200:203], 0
    v_mfma_f32_16x16x32_bf16 v[220:223], v[28:31], v[200:203], 0
    v_mfma_f32_16x16x32_bf16 v[216:219], v[32:35], v[196:199], v[216:219]
    v_mfma_f32_16x16x32_bf16 v[220:223], v[36:39], v[196:199], v[220:223]
    v_mfma_f32_16x16x32_bf16 v[216:219], v[40:43], v[192:195], v[216:219]
    v_mfma_f32_16x16x32_bf16 v[220:223], v[44:47], v[192:195], v[220:223]
    v_add_f32_dpp v210, v211, v210 wave_shr:1 row_mask:0xf bank_mask:0xf bound_ctrl:0
    v_mfma_f32_16x16x32_bf16 v[216:219], v[48:51], v[188:191], v[216:219]
    v_mfma_f32_16x16x32_bf16 v[220:223], v[52:55], v[188:191], v[220:223]
    v_add_f32_dpp v214, v215, v214 wave_shr:1 row_mask:0xf bank_mask:0xf bound_ctrl:0
    v_mfma_f32_16x16x32_bf16 v[216:219], v[56:59], v[184:187], v[216:219]
    v_mfma_f32_16x16x32_bf16 v[220:223], v[60:63], v[184:187], v[220:223]
    v_add_f32_dpp v209, v210, v209 wave_shr:1 row_mask:0xf bank_mask:0xf bound_ctrl:0
    v_mfma_f32_16x16x32_bf16 v[216:219], v[64:67], v[180:183], v[216:219]
    v_mfma_f32_16x16x32_bf16 v[220:223], v[68:71], v[180:183], v[220:223]
    v_add_f32_dpp v213, v214, v213 wave_shr:1 row_mask:0xf bank_mask:0xf bound_ctrl:0
    v_mfma_f32_16x16x32_bf16 v[216:219], v[72:75], v[176:179], v[216:219]
    v_mfma_f32_16x16x32_bf16 v[220:223], v[76:79], v[176:179], v[220:223]
    v_add_f32_dpp v208, v209, v208 wave_shr:1 row_mask:0xf bank_mask:0xf bound_ctrl:0
    v_mfma_f32_16x16x32_bf16 v[216:219], v[80:83], v[172:175], v[216:219]
    v_mfma_f32_16x16x32_bf16 v[220:223], v[84:87], v[172:175], v[220:223]
    v_add_f32_dpp v212, v213, v212 wave_shr:1 row_mask:0xf bank_mask:0xf bound_ctrl:0
    v_mfma_f32_16x16x32_bf16 v[216:219], v[88:91], v[168:171], v[216:219]
    v_mfma_f32_16x16x32_bf16 v[220:223], v[92:95], v[168:171], v[220:223]
    ds_write_b32 v4, v208 offset:3584
    v_mfma_f32_16x16x32_bf16 v[216:219], v[96:99], v[164:167], v[216:219]
    v_mfma_f32_16x16x32_bf16 v[220:223], v[100:103], v[164:167], v[220:223]
    ds_write_b32 v5, v212 offset:3584
    v_mfma_f32_16x16x32_bf16 v[216:219], v[104:107], v[160:163], v[216:219]
    v_mfma_f32_16x16x32_bf16 v[220:223], v[108:111], v[160:163], v[220:223]
    ds_write_b128 v10, v[208:211] offset:448
    v_mfma_f32_16x16x32_bf16 v[216:219], v[112:115], v[156:159], v[216:219]
    v_mfma_f32_16x16x32_bf16 v[220:223], v[116:119], v[156:159], v[220:223]
    ds_write_b128 v10, v[212:215] offset:464
    v_mfma_f32_16x16x32_bf16 v[216:219], v[120:123], v[152:155], v[216:219]
    v_mfma_f32_16x16x32_bf16 v[220:223], v[124:127], v[152:155], v[220:223]
    s_mov_b32 s70, 7864320
    buffer_store_dwordx4 v[232:235], v9, s[8:11], s70 offen sc1
    v_mfma_f32_16x16x32_bf16 v[216:219], v[128:131], v[148:151], v[216:219]
    v_mfma_f32_16x16x32_bf16 v[220:223], v[132:135], v[148:151], v[220:223]
    s_mov_b32 s70, 8519680
    buffer_store_dwordx4 v[236:239], v9, s[8:11], s70 offen sc1
    v_mfma_f32_16x16x32_bf16 v[216:219], v[16:19], v[204:207], v[216:219]
    v_mfma_f32_16x16x32_bf16 v[220:223], v[20:23], v[204:207], v[220:223]
    s_mov_b32 s70, 9175040
    buffer_store_dwordx4 v[240:243], v9, s[8:11], s70 offen sc1
    v_mfma_f32_16x16x32_bf16 v[216:219], v[136:139], v[144:147], v[216:219]
    v_mfma_f32_16x16x32_bf16 v[220:223], v[140:143], v[144:147], v[220:223]
    v_and_b32 v252, 7, v1
    v_lshlrev_b32 v254, 3, v252
    v_lshlrev_b32 v252, 2, v252
    s_lshl_b32 s71, s4, 9
    s_add_u32 s71, s71, 0xec4140
    buffer_load_dword v254, v254, s[52:55], 0 offen sc1
    buffer_load_dword v253, v252, s[8:11], s71 offen sc1
    v_add_f32_dpp v218, v219, v218 wave_shr:1 row_mask:0xf bank_mask:0xf bound_ctrl:0
    v_add_f32_dpp v222, v223, v222 wave_shr:1 row_mask:0xf bank_mask:0xf bound_ctrl:0
    s_nop 0
    v_add_f32_dpp v217, v218, v217 wave_shr:1 row_mask:0xf bank_mask:0xf bound_ctrl:0
    v_add_f32_dpp v221, v222, v221 wave_shr:1 row_mask:0xf bank_mask:0xf bound_ctrl:0
    s_nop 0
    v_add_f32_dpp v216, v217, v216 wave_shr:1 row_mask:0xf bank_mask:0xf bound_ctrl:0
    v_add_f32_dpp v220, v221, v220 wave_shr:1 row_mask:0xf bank_mask:0xf bound_ctrl:0
    ds_write_b32 v4, v216 offset:3840
    ds_write_b32 v5, v220 offset:3840
    ds_write_b128 v10, v[216:219] offset:480
    ds_write_b128 v10, v[220:223] offset:496
    ds_read_b128 v[224:227], v6 offset:3072
    ds_read_b128 v[228:231], v6 offset:3088
    ds_read_b128 v[248:251], v11 offset:384
    v_lshlrev_b32 v12, 16, v244
    v_and_b32 v13, s64, v244
    s_waitcnt lgkmcnt(0)
    v_add_f32 v224, v224, v249
    v_add_f32 v225, v225, v250
    v_add_f32 v226, v226, v251
    v_fmac_f32 v224, s72, v12
    v_fmac_f32 v225, s72, v13
    v_cvt_pk_bf16_f32 v244, v224, v225
    v_lshlrev_b32 v14, 16, v245
    v_and_b32 v15, s64, v245
    v_fmac_f32 v226, s72, v14
    v_fmac_f32 v227, s72, v15
    v_cvt_pk_bf16_f32 v245, v226, v227
    v_lshlrev_b32 v12, 16, v246
    v_and_b32 v13, s64, v246
    v_fmac_f32 v228, s72, v12
    v_fmac_f32 v229, s72, v13
    v_cvt_pk_bf16_f32 v246, v228, v229
    v_lshlrev_b32 v14, 16, v247
    v_and_b32 v15, s64, v247
    v_fmac_f32 v230, s72, v14
    v_fmac_f32 v231, s72, v15
    v_cvt_pk_bf16_f32 v247, v230, v231
    s_mov_b32 s70, 9830400
    buffer_store_dwordx4 v[244:247], v9, s[8:11], s70 offen sc1
    s_waitcnt vmcnt(0)
    s_cmp_eq_u32 s5, 26
    s_cselect_b32 s70, 2, 3
    v_mov_b32 v10, 160132
    v_mov_b32 v11, 1
    s_mov_b64 exec, 1
    ds_add_rtn_u32 v12, v10, v11
    s_mov_b64 exec, -1
    s_waitcnt lgkmcnt(0)
    v_readfirstlane_b32 s78, v12
    s_nop 0
    s_add_u32 s78, s78, 1
    s_cmp_lg_u32 s78, s70
    s_cbranch_scc1 Lnl_22
    s_add_u32 s78, s6, 3
    s_add_u32 s78, s78, s59
    v_mov_b32 v14, s78
    v_mov_b32 v15, 0
    s_lshl_b32 s77, s4, 9
    s_lshl_b32 s76, s5, 2
    s_add_u32 s77, s77, s76
    s_add_u32 s77, s77, 0xec4000
    s_mov_b64 exec, 1
    s_cmp_eq_u32 s12, 1
    s_cbranch_scc1 Lf_23
    buffer_store_dword v14, v15, s[8:11], s77 offen sc1
    s_branch Lg_24
Lf_23:
    buffer_store_dword v14, v15, s[8:11], s77 offen
Lg_24:
    s_mov_b64 exec, -1
Lnl_22:
    v_sub_u32 v253, v253, v254
    v_cmp_ne_u32 vcc, 1, v253
    s_cbranch_vccz L_cvok
    s_mov_b32 s79, 0
Lpoll_25:
    v_and_b32 v252, 7, v1
    v_lshlrev_b32 v254, 3, v252
    v_lshlrev_b32 v252, 2, v252
    s_lshl_b32 s71, s4, 9
    s_add_u32 s71, s71, 0xec4140
    buffer_load_dword v254, v254, s[52:55], 0 offen sc1
    buffer_load_dword v253, v252, s[8:11], s71 offen sc1
    s_waitcnt vmcnt(0)
    v_sub_u32 v253, v253, v254
    v_cmp_ne_u32 vcc, 1, v253
    s_cbranch_vccz Lpd_26
    s_add_u32 s79, s79, 1
    s_cmp_lt_u32 s79, s80
    s_cbranch_scc1 Lpoll_25
    s_mov_b32 s80, 0
Lpd_26:
L_cvok:
    v_mov_b32 v12, 160144
    v_mov_b32 v13, 1
    ds_write_b32 v12, v13
    s_branch L_pre
L_loader:
    v_mov_b32 v8, 0
    v_mov_b32 v9, 0
    v_mov_b32 v10, 0
    v_mov_b32 v11, 0
    s_mov_b32 s60, s38
    s_and_b32 s61, s39, 0xffff
    s_mov_b32 s62, 0x100
    s_mov_b32 s63, 0x20000
    s_cmp_lg_u32 s5, 0
    s_cbranch_scc1 L_notag
    s_memrealtime s[64:65]
    s_waitcnt lgkmcnt(0)
    s_lshl_b32 s64, s64, 4
    s_or_b32 s64, s64, 0x80000000
    v_mov_b32 v12, s64
    v_mov_b32 v13, s7
    s_lshl_b32 s65, s4, 3
    s_mov_b64 exec, 1
    buffer_store_dwordx2 v[12:13], v8, s[60:63], s65 offen sc1
    s_mov_b64 exec, -1
L_notag:
    v_mov_b32 v13, 160128
    ds_write_b128 v13, v[8:11]
    ds_write_b128 v13, v[8:11] offset:16
    s_mov_b32 s44, s16
    s_and_b32 s45, s17, 0xffff
    s_mov_b32 s46, 0x280000
    s_mov_b32 s47, 0x20000
    v_lshrrev_b32 v2, 3, v1
    v_and_b32 v3, 7, v1
    s_lshl_b32 s64, s4, 5
    s_add_u32 s95, s64, s5
    s_lshl_b32 s64, s95, 3
    v_add_u32 v4, s64, v2
    v_mul_u32_u24 v5, 1280, v4
    v_lshl_add_u32 v5, v3, 4, v5
    buffer_load_dwordx4 v[16:19], v5, s[44:47], 0 offen offset:0
    buffer_load_dwordx4 v[20:23], v5, s[44:47], 0 offen offset:128
    buffer_load_dwordx4 v[24:27], v5, s[44:47], 0 offen offset:256
    buffer_load_dwordx4 v[28:31], v5, s[44:47], 0 offen offset:384
    buffer_load_dwordx4 v[32:35], v5, s[44:47], 0 offen offset:512
    buffer_load_dwordx4 v[36:39], v5, s[44:47], 0 offen offset:640
    buffer_load_dwordx4 v[40:43], v5, s[44:47], 0 offen offset:768
    buffer_load_dwordx4 v[44:47], v5, s[44:47], 0 offen offset:896
    buffer_load_dwordx4 v[48:51], v5, s[44:47], 0 offen offset:1024
    buffer_load_dwordx4 v[52:55], v5, s[44:47], 0 offen offset:1152
    s_waitcnt lgkmcnt(0)
    s_barrier
    s_mov_b32 s48, s34
    s_and_b32 s49, s35, 0xffff
    s_mov_b32 s50, 0x1e0000
    s_mov_b32 s51, 0x20000
    s_mov_b32 s52, s30
    s_and_b32 s53, s31, 0xffff
    s_mov_b32 s54, 0x1e0000
    s_mov_b32 s55, 0x20000
    s_mov_b32 s56, s32
    s_and_b32 s57, s33, 0xffff
    s_mov_b32 s58, 0x1e0000
    s_mov_b32 s59, 0x20000
    s_mov_b32 s88, s40
    s_and_b32 s89, s41, 0xffff
    s_mov_b32 s90, 0x10000000
    s_mov_b32 s91, 0x20000
    s_cmp_ge_u32 s2, 192
    s_cselect_b32 s50, 0, s50
    s_cselect_b32 s90, 0, s90
    v_add_u32 v6, 0, v1
    v_mul_u32_u24 v7, 6554, v6
    v_lshrrev_b32 v7, 16, v7
    v_mul_u32_u24 v12, 10, v7
    v_sub_u32 v6, v6, v12
    v_mul_u32_u24 v7, 1280, v7
    v_lshl_add_u32 v60, v6, 4, v7
    v_add_u32 v6, 64, v1
    v_mul_u32_u24 v7, 6554, v6
    v_lshrrev_b32 v7, 16, v7
    v_mul_u32_u24 v12, 10, v7
    v_sub_u32 v6, v6, v12
    v_mul_u32_u24 v7, 1280, v7
    v_lshl_add_u32 v61, v6, 4, v7
    v_add_u32 v6, 128, v1
    v_mul_u32_u24 v7, 6554, v6
    v_lshrrev_b32 v7, 16, v7
    v_mul_u32_u24 v12, 10, v7
    v_sub_u32 v6, v6, v12
    v_mul_u32_u24 v7, 1280, v7
    v_lshl_add_u32 v62, v6, 4, v7
    v_add_u32 v6, 192, v1
    v_mul_u32_u24 v7, 6554, v6
    v_lshrrev_b32 v7, 16, v7
    v_mul_u32_u24 v12, 10, v7
    v_sub_u32 v6, v6, v12
    v_mul_u32_u24 v7, 1280, v7
    v_lshl_add_u32 v63, v6, 4, v7
    v_add_u32 v6, 256, v1
    v_mul_u32_u24 v7, 6554, v6
    v_lshrrev_b32 v7, 16, v7
    v_mul_u32_u24 v12, 10, v7
    v_sub_u32 v6, v6, v12
    v_mul_u32_u24 v7, 1280, v7
    v_lshl_add_u32 v64, v6, 4, v7
    s_lshl_b32 s65, s2, 1
    s_add_u32 s65, s65, 0
    s_and_b32 s66, s65, 7
    s_lshr_b32 s67, s65, 3
    s_mul_i32 s68, s67, 40960
    s_mul_i32 s69, s66, 160
    s_add_u32 s83, s68, s69
    s_mul_i32 s69, s66, 48
    s_add_u32 s69, s69, s67
    s_mul_i32 s69, s69, 5120
    s_add_u32 s70, s69, 0xc80000
    s_lshl_b32 s65, s2, 1
    s_add_u32 s65, s65, 1
    s_and_b32 s66, s65, 7
    s_lshr_b32 s67, s65, 3
    s_mul_i32 s68, s67, 40960
    s_mul_i32 s69, s66, 160
    s_add_u32 s84, s68, s69
    s_mul_i32 s69, s66, 48
    s_add_u32 s69, s69, s67
    s_mul_i32 s69, s69, 5120
    s_add_u32 s71, s69, 0xc80000
    v_lshlrev_b32 v7, 4, v1
    v_add_u32 v6, 0, v1
    v_mul_u32_u24 v8, 10923, v6
    v_lshrrev_b32 v8, 16, v8
    v_mul_u32_u24 v9, 6, v8
    v_sub_u32 v6, v6, v9
    v_mul_u32_u24 v8, 3072, v8
    v_lshl_add_u32 v66, v6, 4, v8
    v_subrev_u32 v66, 0, v66
    v_add_u32 v6, 64, v1
    v_mul_u32_u24 v8, 10923, v6
    v_lshrrev_b32 v8, 16, v8
    v_mul_u32_u24 v9, 6, v8
    v_sub_u32 v6, v6, v9
    v_mul_u32_u24 v8, 3072, v8
    v_lshl_add_u32 v67, v6, 4, v8
    v_subrev_u32 v67, 1024, v67
    v_add_u32 v6, 128, v1
    v_mul_u32_u24 v8, 10923, v6
    v_lshrrev_b32 v8, 16, v8
    v_mul_u32_u24 v9, 6, v8
    v_sub_u32 v6, v6, v9
    v_mul_u32_u24 v8, 3072, v8
    v_lshl_add_u32 v68, v6, 4, v8
    v_subrev_u32 v68, 2048, v68
    s_mul_i32 s72, s5, 96
    s_mov_b32 s73, 0
    s_mov_b32 s82, 0
    s_mov_b32 s64, 0xffff0000
    v_mov_b32 v56, 0
    v_mov_b32 v57, 0
    v_mov_b32 v58, 0
    v_mov_b32 v59, 0
    v_lshrrev_b32 v69, 3, v1
    v_lshlrev_b32 v69, 3, v69
    v_bfe_u32 v72, v1, 2, 2
    v_lshrrev_b32 v73, 4, v1
    v_lshl_add_u32 v72, v73, 2, v72
    v_and_b32 v73, 3, v1
    v_mul_u32_u24 v71, 96, v72
    v_lshl_add_u32 v71, v73, 3, v71
    v_mul_u32_u24 v74, 160, v72
    v_lshl_add_u32 v74, v73, 3, v74
    v_add_u32 v74, 112640, v74
    s_mov_b32 m0, 112640
    s_nop 0
    buffer_load_dwordx4 v60, s[48:51], s83 offen lds
    s_mov_b32 m0, 113664
    s_nop 0
    buffer_load_dwordx4 v61, s[48:51], s83 offen lds
    s_mov_b32 m0, 114688
    s_nop 0
    buffer_load_dwordx4 v62, s[48:51], s83 offen lds
    s_mov_b32 m0, 115712
    s_nop 0
    buffer_load_dwordx4 v63, s[48:51], s83 offen lds
    s_mov_b32 m0, 116736
    s_nop 0
    buffer_load_dwordx4 v64, s[48:51], s83 offen lds
    s_mov_b32 m0, 117760
    s_nop 0
    buffer_load_dwordx4 v60, s[48:51], s84 offen lds
    s_mov_b32 m0, 118784
    s_nop 0
    buffer_load_dwordx4 v61, s[48:51], s84 offen lds
    s_mov_b32 m0, 119808
    s_nop 0
    buffer_load_dwordx4 v62, s[48:51], s84 offen lds
    s_mov_b32 m0, 120832
    s_nop 0
    buffer_load_dwordx4 v63, s[48:51], s84 offen lds
    s_mov_b32 m0, 121856
    s_nop 0
    buffer_load_dwordx4 v64, s[48:51], s84 offen lds
    s_waitcnt vmcnt(15)
    buffer_load_dword v70, v69, s[60:63], 0 offen sc1
    s_waitcnt vmcnt(11)
    s_add_u32 m0, s73, 0
    s_nop 0
    buffer_load_dwordx4 v66, s[52:55], s72 offen offset:0 lds
    buffer_load_dwordx4 v67, s[52:55], s72 offen offset:1024 lds
    buffer_load_dwordx4 v68, s[52:55], s72 offen offset:2048 lds
    s_add_u32 m0, s73, 61440
    s_nop 0
    buffer_load_dwordx4 v66, s[56:59], s72 offen offset:0 lds
    buffer_load_dwordx4 v67, s[56:59], s72 offen offset:1024 lds
    buffer_load_dwordx4 v68, s[56:59], s72 offen offset:2048 lds
    s_add_u32 s72, s72, 98304
    s_add_u32 s73, s73, 3072
    s_add_u32 m0, s73, 0
    s_nop 0
    buffer_load_dwordx4 v66, s[52:55], s72 offen offset:0 lds
    buffer_load_dwordx4 v67, s[52:55], s72 offen offset:1024 lds
    buffer_load_dwordx4 v68, s[52:55], s72 offen offset:2048 lds
    s_add_u32 m0, s73, 61440
    s_nop 0
    buffer_load_dwordx4 v66, s[56:59], s72 offen offset:0 lds
    buffer_load_dwordx4 v67, s[56:59], s72 offen offset:1024 lds
    buffer_load_dwordx4 v68, s[56:59], s72 offen offset:2048 lds
    s_add_u32 s72, s72, 98304
    s_add_u32 s73, s73, 3072
    v_lshlrev_b32 v8, 16, v16
    v_and_b32 v9, s64, v16
    v_pk_add_f32 v[56:57], v[56:57], v[8:9]
    v_pk_fma_f32 v[58:59], v[8:9], v[8:9], v[58:59]
    v_lshlrev_b32 v10, 16, v17
    v_and_b32 v11, s64, v17
    v_pk_add_f32 v[56:57], v[56:57], v[10:11]
    v_pk_fma_f32 v[58:59], v[10:11], v[10:11], v[58:59]
    v_lshlrev_b32 v8, 16, v18
    v_and_b32 v9, s64, v18
    v_pk_add_f32 v[56:57], v[56:57], v[8:9]
    v_pk_fma_f32 v[58:59], v[8:9], v[8:9], v[58:59]
    v_lshlrev_b32 v10, 16, v19
    v_and_b32 v11, s64, v19
    v_pk_add_f32 v[56:57], v[56:57], v[10:11]
    v_pk_fma_f32 v[58:59], v[10:11], v[10:11], v[58:59]
    v_lshlrev_b32 v8, 16, v20
    v_and_b32 v9, s64, v20
    v_pk_add_f32 v[56:57], v[56:57], v[8:9]
    v_pk_fma_f32 v[58:59], v[8:9], v[8:9], v[58:59]
    v_lshlrev_b32 v10, 16, v21
    v_and_b32 v11, s64, v21
    v_pk_add_f32 v[56:57], v[56:57], v[10:11]
    v_pk_fma_f32 v[58:59], v[10:11], v[10:11], v[58:59]
    v_lshlrev_b32 v8, 16, v22
    v_and_b32 v9, s64, v22
    v_pk_add_f32 v[56:57], v[56:57], v[8:9]
    v_pk_fma_f32 v[58:59], v[8:9], v[8:9], v[58:59]
    v_lshlrev_b32 v10, 16, v23
    v_and_b32 v11, s64, v23
    v_pk_add_f32 v[56:57], v[56:57], v[10:11]
    v_pk_fma_f32 v[58:59], v[10:11], v[10:11], v[58:59]
    v_lshlrev_b32 v8, 16, v24
    v_and_b32 v9, s64, v24
    v_pk_add_f32 v[56:57], v[56:57], v[8:9]
    v_pk_fma_f32 v[58:59], v[8:9], v[8:9], v[58:59]
    v_lshlrev_b32 v10, 16, v25
    v_and_b32 v11, s64, v25
    v_pk_add_f32 v[56:57], v[56:57], v[10:11]
    v_pk_fma_f32 v[58:59], v[10:11], v[10:11], v[58:59]
    v_lshlrev_b32 v8, 16, v26
    v_and_b32 v9, s64, v26
    v_pk_add_f32 v[56:57], v[56:57], v[8:9]
    v_pk_fma_f32 v[58:59], v[8:9], v[8:9], v[58:59]
    v_lshlrev_b32 v10, 16, v27
    v_and_b32 v11, s64, v27
    v_pk_add_f32 v[56:57], v[56:57], v[10:11]
    v_pk_fma_f32 v[58:59], v[10:11], v[10:11], v[58:59]
    v_lshlrev_b32 v8, 16, v28
    v_and_b32 v9, s64, v28
    v_pk_add_f32 v[56:57], v[56:57], v[8:9]
    v_pk_fma_f32 v[58:59], v[8:9], v[8:9], v[58:59]
    v_lshlrev_b32 v10, 16, v29
    v_and_b32 v11, s64, v29
    v_pk_add_f32 v[56:57], v[56:57], v[10:11]
    v_pk_fma_f32 v[58:59], v[10:11], v[10:11], v[58:59]
    v_lshlrev_b32 v8, 16, v30
    v_and_b32 v9, s64, v30
    v_pk_add_f32 v[56:57], v[56:57], v[8:9]
    v_pk_fma_f32 v[58:59], v[8:9], v[8:9], v[58:59]
    v_lshlrev_b32 v10, 16, v31
    v_and_b32 v11, s64, v31
    v_pk_add_f32 v[56:57], v[56:57], v[10:11]
    v_pk_fma_f32 v[58:59], v[10:11], v[10:11], v[58:59]
    v_lshlrev_b32 v8, 16, v32
    v_and_b32 v9, s64, v32
    v_pk_add_f32 v[56:57], v[56:57], v[8:9]
    v_pk_fma_f32 v[58:59], v[8:9], v[8:9], v[58:59]
    v_lshlrev_b32 v10, 16, v33
    v_and_b32 v11, s64, v33
    v_pk_add_f32 v[56:57], v[56:57], v[10:11]
    v_pk_fma_f32 v[58:59], v[10:11], v[10:11], v[58:59]
    v_lshlrev_b32 v8, 16, v34
    v_and_b32 v9, s64, v34
    v_pk_add_f32 v[56:57], v[56:57], v[8:9]
    v_pk_fma_f32 v[58:59], v[8:9], v[8:9], v[58:59]
    v_lshlrev_b32 v10, 16, v35
    v_and_b32 v11, s64, v35
    v_pk_add_f32 v[56:57], v[56:57], v[10:11]
    v_pk_fma_f32 v[58:59], v[10:11], v[10:11], v[58:59]
    v_lshlrev_b32 v8, 16, v36
    v_and_b32 v9, s64, v36
    v_pk_add_f32 v[56:57], v[56:57], v[8:9]
    v_pk_fma_f32 v[58:59], v[8:9], v[8:9], v[58:59]
    v_lshlrev_b32 v10, 16, v37
    v_and_b32 v11, s64, v37
    v_pk_add_f32 v[56:57], v[56:57], v[10:11]
    v_pk_fma_f32 v[58:59], v[10:11], v[10:11], v[58:59]
    v_lshlrev_b32 v8, 16, v38
    v_and_b32 v9, s64, v38
    v_pk_add_f32 v[56:57], v[56:57], v[8:9]
    v_pk_fma_f32 v[58:59], v[8:9], v[8:9], v[58:59]
    v_lshlrev_b32 v10, 16, v39
    v_and_b32 v11, s64, v39
    v_pk_add_f32 v[56:57], v[56:57], v[10:11]
    v_pk_fma_f32 v[58:59], v[10:11], v[10:11], v[58:59]
    v_lshlrev_b32 v8, 16, v40
    v_and_b32 v9, s64, v40
    v_pk_add_f32 v[56:57], v[56:57], v[8:9]
    v_pk_fma_f32 v[58:59], v[8:9], v[8:9], v[58:59]
    v_lshlrev_b32 v10, 16, v41
    v_and_b32 v11, s64, v41
    v_pk_add_f32 v[56:57], v[56:57], v[10:11]
    v_pk_fma_f32 v[58:59], v[10:11], v[10:11], v[58:59]
    v_lshlrev_b32 v8, 16, v42
    v_and_b32 v9, s64, v42
    v_pk_add_f32 v[56:57], v[56:57], v[8:9]
    v_pk_fma_f32 v[58:59], v[8:9], v[8:9], v[58:59]
    v_lshlrev_b32 v10, 16, v43
    v_and_b32 v11, s64, v43
    v_pk_add_f32 v[56:57], v[56:57], v[10:11]
    v_pk_fma_f32 v[58:59], v[10:11], v[10:11], v[58:59]
    v_lshlrev_b32 v8, 16, v44
    v_and_b32 v9, s64, v44
    v_pk_add_f32 v[56:57], v[56:57], v[8:9]
    v_pk_fma_f32 v[58:59], v[8:9], v[8:9], v[58:59]
    v_lshlrev_b32 v10, 16, v45
    v_and_b32 v11, s64, v45
    v_pk_add_f32 v[56:57], v[56:57], v[10:11]
    v_pk_fma_f32 v[58:59], v[10:11], v[10:11], v[58:59]
    v_lshlrev_b32 v8, 16, v46
    v_and_b32 v9, s64, v46
    v_pk_add_f32 v[56:57], v[56:57], v[8:9]
    v_pk_fma_f32 v[58:59], v[8:9], v[8:9], v[58:59]
    v_lshlrev_b32 v10, 16, v47
    v_and_b32 v11, s64, v47
    v_pk_add_f32 v[56:57], v[56:57], v[10:11]
    v_pk_fma_f32 v[58:59], v[10:11], v[10:11], v[58:59]
    v_lshlrev_b32 v8, 16, v48
    v_and_b32 v9, s64, v48
    v_pk_add_f32 v[56:57], v[56:57], v[8:9]
    v_pk_fma_f32 v[58:59], v[8:9], v[8:9], v[58:59]
    v_lshlrev_b32 v10, 16, v49
    v_and_b32 v11, s64, v49
    v_pk_add_f32 v[56:57], v[56:57], v[10:11]
    v_pk_fma_f32 v[58:59], v[10:11], v[10:11], v[58:59]
    v_lshlrev_b32 v8, 16, v50
    v_and_b32 v9, s64, v50
    v_pk_add_f32 v[56:57], v[56:57], v[8:9]
    v_pk_fma_f32 v[58:59], v[8:9], v[8:9], v[58:59]
    v_lshlrev_b32 v10, 16, v51
    v_and_b32 v11, s64, v51
    v_pk_add_f32 v[56:57], v[56:57], v[10:11]
    v_pk_fma_f32 v[58:59], v[10:11], v[10:11], v[58:59]
    v_lshlrev_b32 v8, 16, v52
    v_and_b32 v9, s64, v52
    v_pk_add_f32 v[56:57], v[56:57], v[8:9]
    v_pk_fma_f32 v[58:59], v[8:9], v[8:9], v[58:59]
    v_lshlrev_b32 v10, 16, v53
    v_and_b32 v11, s64, v53
    v_pk_add_f32 v[56:57], v[56:57], v[10:11]
    v_pk_fma_f32 v[58:59], v[10:11], v[10:11], v[58:59]
    v_lshlrev_b32 v8, 16, v54
    v_and_b32 v9, s64, v54
    v_pk_add_f32 v[56:57], v[56:57], v[8:9]
    v_pk_fma_f32 v[58:59], v[8:9], v[8:9], v[58:59]
    v_lshlrev_b32 v10, 16, v55
    v_and_b32 v11, s64, v55
    v_pk_add_f32 v[56:57], v[56:57], v[10:11]
    v_pk_fma_f32 v[58:59], v[10:11], v[10:11], v[58:59]
    v_add_f32 v56, v56, v57
    v_add_f32 v58, v58, v59
    s_nop 0
    v_add_f32_dpp v56, v56, v56 quad_perm:[1,0,3,2] row_mask:0xf bank_mask:0xf
    v_add_f32_dpp v58, v58, v58 quad_perm:[1,0,3,2] row_mask:0xf bank_mask:0xf
    s_nop 0
    v_add_f32_dpp v56, v56, v56 quad_perm:[2,3,0,1] row_mask:0xf bank_mask:0xf
    v_add_f32_dpp v58, v58, v58 quad_perm:[2,3,0,1] row_mask:0xf bank_mask:0xf
    s_nop 0
    v_add_f32_dpp v56, v56, v56 row_half_mirror row_mask:0xf bank_mask:0xf
    v_add_f32_dpp v58, v58, v58 row_half_mirror row_mask:0xf bank_mask:0xf
    v_mul_f32 v56, 0x3acccccd, v56
    v_mul_f32 v58, 0x3acccccd, v58
    v_fma_f32 v58, -v56, v56, v58
    v_max_f32 v58, 0, v58
    v_add_f32 v58, 0x3727c5ac, v58
    v_rsq_f32 v58, v58
    v_lshlrev_b32 v6, 2, v2
    v_add_u32 v6, 160192, v6
    v_mul_f32_e64 v56, -v56, v58
    ds_write_b32 v6, v58
    ds_write_b32 v6, v56 offset:32
    v_and_b32 v6, 3, v1
    v_lshlrev_b32 v8, 4, v6
    v_add_u32 v8, 160192, v8
    ds_read_b128 v[56:59], v8
    v_and_b32 v8, 1, v1
    v_lshlrev_b32 v8, 4, v8
    v_lshrrev_b32 v6, 1, v6
    v_lshl_add_u32 v8, v6, 13, v8
    s_lshl_b32 s65, s95, 5
    s_add_u32 s65, s65, 0xe60000
    s_waitcnt lgkmcnt(0)
    s_mov_b64 exec, 15
    buffer_store_dwordx4 v[56:59], v8, s[8:11], s65 offen sc1
    s_mov_b64 exec, -1
    s_mov_b32 s66, 0x3f803f80
    v_mov_b32 v80, 0
    v_mov_b32 v81, 0
    v_mov_b32 v82, 0
    v_mov_b32 v83, 0
    v_mov_b32 v84, 0
    v_mov_b32 v85, 0
    v_mov_b32 v86, 0
    v_mov_b32 v87, 0
    v_mov_b32 v88, 0
    v_mov_b32 v89, 0
    v_mov_b32 v90, 0
    v_mov_b32 v91, 0
    v_mov_b32 v92, 0
    v_mov_b32 v93, 0
    v_mov_b32 v94, 0
    v_mov_b32 v95, 0
    v_mov_b32 v96, 0
    v_mov_b32 v97, 0
    v_mov_b32 v98, 0
    v_mov_b32 v99, 0
    v_mov_b32 v100, 0
    v_mov_b32 v101, 0
    v_mov_b32 v102, 0
    v_mov_b32 v103, 0
    v_mov_b32 v16, 0
    v_mov_b32 v17, 0
    v_mov_b32 v18, 0
    v_mov_b32 v19, 0
    v_mov_b32 v20, 0
    v_mov_b32 v21, 0
    v_mov_b32 v22, 0
    v_mov_b32 v23, 0
    v_mov_b32 v24, 0
    v_mov_b32 v25, 0
    v_mov_b32 v26, 0
    v_mov_b32 v27, 0
    v_mov_b32 v28, 0
    v_mov_b32 v29, 0
    v_mov_b32 v30, 0
    v_mov_b32 v31, 0
    v_mov_b32 v32, 0
    v_mov_b32 v33, 0
    v_mov_b32 v34, 0
    v_mov_b32 v35, 0
    v_mov_b32 v36, 0
    v_mov_b32 v37, 0
    v_mov_b32 v38, 0
    v_mov_b32 v39, 0
    s_mov_b32 s67, 0
    s_mov_b32 s69, 0
    v_mov_b32 v49, 0
    v_mov_b32 v48, 160156
    v_mov_b32 v12, s66
    v_mov_b32 v13, s66
    v_mov_b32 v14, s66
    v_mov_b32 v15, s66
    v_mov_b32 v44, -1
    v_mov_b32 v45, -1
    v_mov_b32 v46, -1
    v_mov_b32 v47, -1
    s_lshl_b32 s65, s2, 10
    s_add_u32 s65, s65, 0xe64000
    buffer_store_dwordx4 v[44:47], v7, s[8:11], s65 offen sc1
    s_waitcnt vmcnt(15)
    ds_read_b64_tr_b16 v[104:105], v74 offset:0
    ds_read_b64_tr_b16 v[106:107], v74 offset:2560
    ds_read_b64_tr_b16 v[108:109], v74 offset:32
    ds_read_b64_tr_b16 v[110:111], v74 offset:2592
    ds_read_b64_tr_b16 v[112:113], v74 offset:64
    ds_read_b64_tr_b16 v[114:115], v74 offset:2624
    ds_read_b64_tr_b16 v[116:117], v74 offset:96
    ds_read_b64_tr_b16 v[118:119], v74 offset:2656
    ds_read_b64_tr_b16 v[120:121], v74 offset:128
    ds_read_b64_tr_b16 v[122:123], v74 offset:2688
    ds_read_b64_tr_b16 v[124:125], v74 offset:5120
    ds_read_b64_tr_b16 v[126:127], v74 offset:7680
    ds_read_b64_tr_b16 v[128:129], v74 offset:5152
    ds_read_b64_tr_b16 v[130:131], v74 offset:7712
    ds_read_b64_tr_b16 v[132:133], v74 offset:5184
    ds_read_b64_tr_b16 v[134:135], v74 offset:7744
    ds_read_b64_tr_b16 v[136:137], v74 offset:5216
    ds_read_b64_tr_b16 v[138:139], v74 offset:7776
    ds_read_b64_tr_b16 v[140:141], v74 offset:5248
    ds_read_b64_tr_b16 v[142:143], v74 offset:7808
    s_waitcnt lgkmcnt(15)
    buffer_store_dwordx4 v[104:107], v7, s[88:91], s70 offen offset:0 sc1
    buffer_store_dwordx4 v[108:111], v7, s[88:91], s70 offen offset:1024 sc1
    s_waitcnt lgkmcnt(14)
    buffer_store_dwordx4 v[112:115], v7, s[88:91], s70 offen offset:2048 sc1
    s_waitcnt lgkmcnt(12)
    buffer_store_dwordx4 v[116:119], v7, s[88:91], s70 offen offset:3072 sc1
    s_waitcnt lgkmcnt(10)
    s_add_u32 s70, s70, 4096
    buffer_store_dwordx4 v[120:123], v7, s[88:91], s70 offen offset:0 sc1
    s_waitcnt lgkmcnt(8)
    buffer_store_dwordx4 v[124:127], v7, s[88:91], s71 offen offset:0 sc1
    s_waitcnt lgkmcnt(6)
    buffer_store_dwordx4 v[128:131], v7, s[88:91], s71 offen offset:1024 sc1
    s_waitcnt lgkmcnt(4)
    buffer_store_dwordx4 v[132:135], v7, s[88:91], s71 offen offset:2048 sc1
    s_waitcnt lgkmcnt(2)
    buffer_store_dwordx4 v[136:139], v7, s[88:91], s71 offen offset:3072 sc1
    s_waitcnt lgkmcnt(0)
    s_add_u32 s71, s71, 4096
    buffer_store_dwordx4 v[140:143], v7, s[88:91], s71 offen offset:0 sc1
    s_add_u32 m0, s73, 0
    s_nop 0
    buffer_load_dwordx4 v66, s[52:55], s72 offen offset:0 lds
    buffer_load_dwordx4 v67, s[52:55], s72 offen offset:1024 lds
    buffer_load_dwordx4 v68, s[52:55], s72 offen offset:2048 lds
    s_add_u32 m0, s73, 61440
    s_nop 0
    buffer_load_dwordx4 v66, s[56:59], s72 offen offset:0 lds
    buffer_load_dwordx4 v67, s[56:59], s72 offen offset:1024 lds
    buffer_load_dwordx4 v68, s[56:59], s72 offen offset:2048 lds
    s_add_u32 s72, s72, 98304
    s_add_u32 s73, s73, 3072
    s_waitcnt vmcnt(6)
    v_cmp_eq_u32 vcc, 0, v70
    s_cbranch_vccz L_dbgok
    s_mov_b32 s79, 0
Lpoll_27:
    buffer_load_dword v70, v69, s[60:63], 0 offen sc1
    s_waitcnt vmcnt(0)
    v_cmp_eq_u32 vcc, 0, v70
    s_cbranch_vccz Lpd_28
    s_add_u32 s79, s79, 1
    s_cmp_lt_u32 s79, s80
    s_cbranch_scc1 Lpoll_27
    s_mov_b32 s80, 0
Lpd_28:
L_dbgok:
    s_lshl_b32 s76, s4, 3
    v_readlane_b32 s6, v70, s76
    s_nop 0
    s_add_u32 s78, s6, 1
    v_mov_b32 v8, s78
    v_mov_b32 v9, 0
    v_add_u32 v75, 1, v8
    s_lshl_b32 s77, s4, 9
    s_lshl_b32 s76, s5, 2
    s_add_u32 s77, s77, s76
    s_add_u32 s77, s77, 0xec4080
    s_add_u32 s85, s77, 4096
    s_mov_b64 exec, 1
    buffer_store_dword v75, v9, s[8:11], s85 offen sc1
    s_mov_b64 exec, -1
    s_add_u32 m0, s73, 0
    s_nop 0
    buffer_load_dwordx4 v66, s[52:55], s72 offen offset:0 lds
    buffer_load_dwordx4 v67, s[52:55], s72 offen offset:1024 lds
    buffer_load_dwordx4 v68, s[52:55], s72 offen offset:2048 lds
    s_add_u32 m0, s73, 61440
    s_nop 0
    buffer_load_dwordx4 v66, s[56:59], s72 offen offset:0 lds
    buffer_load_dwordx4 v67, s[56:59], s72 offen offset:1024 lds
    buffer_load_dwordx4 v68, s[56:59], s72 offen offset:2048 lds
    s_add_u32 s72, s72, 98304
    s_add_u32 s73, s73, 3072
L_w1:
    s_cmp_ge_u32 s67, 16
    s_cbranch_scc1 L_w1n
    s_waitcnt vmcnt(6)
L_w1a:
    s_add_u32 m0, s73, 0
    s_nop 0
    buffer_load_dwordx4 v66, s[52:55], s72 offen offset:0 lds
    buffer_load_dwordx4 v67, s[52:55], s72 offen offset:1024 lds
    buffer_load_dwordx4 v68, s[52:55], s72 offen offset:2048 lds
    s_add_u32 m0, s73, 61440
    s_nop 0
    buffer_load_dwordx4 v66, s[56:59], s72 offen offset:0 lds
    buffer_load_dwordx4 v67, s[56:59], s72 offen offset:1024 lds
    buffer_load_dwordx4 v68, s[56:59], s72 offen offset:2048 lds
    s_add_u32 s72, s72, 98304
    s_add_u32 s73, s73, 3072
    s_branch L_w1m
L_w1n:
    s_cmp_lt_u32 s67, 19
    s_cbranch_scc1 L_w1o
    s_waitcnt vmcnt(0)
L_w1o:
    s_waitcnt vmcnt(6)
L_w1m:
    v_add_u32 v4, s82, v71
    v_add_u32 v5, 61440, v4
    s_add_u32 s82, s82, 3072
    s_waitcnt lgkmcnt(0)
    v_mfma_f32_16x16x32_bf16 v[80:83], v[16:19], v[12:15], v[80:83]
    v_mfma_f32_16x16x32_bf16 v[84:87], v[20:23], v[12:15], v[84:87]
    ds_read_b64_tr_b16 v[16:17], v4 offset:0
    ds_read_b64_tr_b16 v[18:19], v4 offset:1536
    v_mfma_f32_16x16x32_bf16 v[88:91], v[24:27], v[12:15], v[88:91]
    ds_read_b64_tr_b16 v[20:21], v5 offset:0
    ds_read_b64_tr_b16 v[22:23], v5 offset:1536
    v_mfma_f32_16x16x32_bf16 v[92:95], v[28:31], v[12:15], v[92:95]
    ds_read_b64_tr_b16 v[24:25], v4 offset:32
    ds_read_b64_tr_b16 v[26:27], v4 offset:1568
    v_mfma_f32_16x16x32_bf16 v[96:99], v[32:35], v[12:15], v[96:99]
    ds_read_b64_tr_b16 v[28:29], v5 offset:32
    ds_read_b64_tr_b16 v[30:31], v5 offset:1568
    v_mfma_f32_16x16x32_bf16 v[100:103], v[36:39], v[12:15], v[100:103]
    ds_read_b64_tr_b16 v[32:33], v4 offset:64
    ds_read_b64_tr_b16 v[34:35], v4 offset:1600
    s_nop 3
    ds_read_b64_tr_b16 v[36:37], v5 offset:64
    ds_read_b64_tr_b16 v[38:39], v5 offset:1600
    s_add_u32 s67, s67, 1
    s_cmp_lt_u32 s67, 20
    s_cbranch_scc1 L_w1
    s_waitcnt lgkmcnt(0)
    v_mfma_f32_16x16x32_bf16 v[80:83], v[16:19], v[12:15], v[80:83]
    v_mfma_f32_16x16x32_bf16 v[84:87], v[20:23], v[12:15], v[84:87]
    v_mfma_f32_16x16x32_bf16 v[88:91], v[24:27], v[12:15], v[88:91]
    v_mfma_f32_16x16x32_bf16 v[92:95], v[28:31], v[12:15], v[92:95]
    v_mfma_f32_16x16x32_bf16 v[96:99], v[32:35], v[12:15], v[96:99]
    v_mfma_f32_16x16x32_bf16 v[100:103], v[36:39], v[12:15], v[100:103]
    v_and_b32 v30, 7, v1
    v_lshlrev_b32 v30, 5, v30
    ds_bpermute_b32 v35, v30, v70
    s_waitcnt lgkmcnt(0)
    v_add_u32 v35, 1, v35
    v_mov_b32 v44, 160144
    s_mov_b32 s79, 0
Llw_29:
    ds_read_b32 v45, v44
    s_waitcnt lgkmcnt(0)
    v_cmp_eq_u32 vcc, 0, v45
    s_cbranch_vccz Lld_30
    s_add_u32 s79, s79, 1
    s_lshr_b32 s81, s79, 3
    s_cmp_lt_u32 s81, s80
    s_cbranch_scc1 Llw_29
    s_mov_b32 s80, 0
Lld_30:
    v_lshrrev_b32 v6, 4, v1
    v_lshlrev_b32 v6, 4, v6
    s_lshl_b32 s65, s2, 9
    s_add_u32 s65, s65, 0xea4000
    s_mov_b32 s66, 0x00010001
    s_nop 7
    s_mov_b32 exec_lo, s66
    s_mov_b32 exec_hi, s66
    buffer_store_dwordx4 v[80:83], v6, s[8:11], s65 offen offset:0
    buffer_store_dwordx4 v[84:87], v6, s[8:11], s65 offen offset:64
    buffer_store_dwordx4 v[88:91], v6, s[8:11], s65 offen offset:128
    buffer_store_dwordx4 v[92:95], v6, s[8:11], s65 offen offset:192
    buffer_store_dwordx4 v[96:99], v6, s[8:11], s65 offen offset:256
    buffer_store_dwordx4 v[100:103], v6, s[8:11], s65 offen offset:320
    s_mov_b64 exec, -1
    v_mov_b32 v8, 160136
    s_mov_b32 s79, 0
Llw_31:
    ds_read_b32 v9, v8
    s_waitcnt lgkmcnt(0)
    v_cmp_eq_u32 vcc, 0, v9
    s_cbranch_vccz Lld_32
    s_add_u32 s79, s79, 1
    s_lshr_b32 s81, s79, 3
    s_cmp_lt_u32 s81, s80
    s_cbranch_scc1 Llw_31
    s_mov_b32 s80, 0
Lld_32:
    v_readfirstlane_b32 s12, v9
    s_nop 0
    s_lshr_b32 s12, s12, 1
    ds_read_b32 v9, v8 offset:4
    s_waitcnt lgkmcnt(0)
    v_readfirstlane_b32 s6, v9
    s_lshl_b32 s59, s12, 3
    s_xor_b32 s59, s59, 8
    s_mov_b32 s94, 160384
L_pre:
    s_cmp_lg_u32 s3, 1
    s_cbranch_scc1 L_nocpf2
    s_getpc_b64 s[76:77]
    s_lshl_b32 s78, s5, 3
    v_and_b32 v60, 7, v1
    v_add_lshl_u32 v60, v60, s78, 7
    v_min_u32 v60, CODE_SPAN2, v60
    global_load_dword v63, v60, s[76:77]
L_nocpf2:
    s_mov_b32 s44, s16
    s_and_b32 s45, s17, 0xffff
    s_mov_b32 s46, 0x280000
    s_mov_b32 s47, 0x20000
    s_lshl_b32 s76, s4, 2
    s_lshr_b32 s77, s5, 3
    s_add_u32 s76, s76, s77
    s_lshl_b32 s76, s76, 2
    s_add_u32 s76, s76, s3
    s_lshl_b32 s76, s76, 6
    s_mul_i32 s77, s76, 320
    s_and_b32 s78, s5, 7
    s_mul_i32 s78, s78, 160
    s_add_u32 s77, s77, s78
    s_mov_b32 m0, s94
    v_add_u32 v60, 0, v1
    v_mul_u32_u24 v61, 6554, v60
    v_lshrrev_b32 v61, 16, v61
    v_mul_u32_u24 v62, 1120, v61
    v_lshl_add_u32 v60, v60, 4, v62
    buffer_load_dwordx4 v60, s[44:47], s77 offen offset:0 lds
    v_add_u32 v60, 64, v1
    v_mul_u32_u24 v61, 6554, v60
    v_lshrrev_b32 v61, 16, v61
    v_mul_u32_u24 v62, 1120, v61
    v_lshl_add_u32 v60, v60, 4, v62
    v_subrev_u32 v60, 1024, v60
    buffer_load_dwordx4 v60, s[44:47], s77 offen offset:1024 lds
    v_add_u32 v60, 128, v1
    v_mul_u32_u24 v61, 6554, v60
    v_lshrrev_b32 v61, 16, v61
    v_mul_u32_u24 v62, 1120, v61
    v_lshl_add_u32 v60, v60, 4, v62
    v_subrev_u32 v60, 2048, v60
    buffer_load_dwordx4 v60, s[44:47], s77 offen offset:2048 lds
    v_lshrrev_b32 v60, 4, v1
    v_lshlrev_b32 v60, 4, v60
    s_add_u32 s76, s76, 0xe60000
    s_add_u32 s77, s76, 0x2000
    buffer_load_dwordx4 v[64:67], v60, s[8:11], s76 offen sc1
    buffer_load_dwordx4 v[68:71], v60, s[8:11], s77 offen sc1
    s_and_b32 s96, s5, 7
    s_mul_i32 s96, s96, 48
    s_mul_i32 s97, s3, 12
    s_add_u32 s96, s96, s97
    s_mul_i32 s96, s96, 5120
    s_add_u32 s96, s96, 0xc80000
    v_lshlrev_b32 v62, 4, v1
    s_add_u32 s97, s96, 0
    buffer_load_dwordx4 a[0:3], v62, s[8:11], s97 offen offset:0 sc1
    buffer_load_dwordx4 a[4:7], v62, s[8:11], s97 offen offset:1024 sc1
    buffer_load_dwordx4 a[8:11], v62, s[8:11], s97 offen offset:2048 sc1
    buffer_load_dwordx4 a[12:15], v62, s[8:11], s97 offen offset:3072 sc1
    s_lshl_b32 s64, s3, 13
    s_add_u32 s64, s64, 122880
    v_lshrrev_b32 v12, 3, v1
    v_bfe_u32 v13, v12, 1, 2
    v_lshlrev_b32 v13, 1, v13
    v_and_b32 v14, 7, v1
    v_xor_b32 v13, v14, v13
    v_lshlrev_b32 v13, 4, v13
    s_add_u32 s97, s96, 4096
    buffer_load_dwordx4 a[16:19], v62, s[8:11], s97 offen offset:0 sc1
    v_lshl_add_u32 v2, v12, 7, v13
    v_xor_b32 v13, v14, v12
    v_lshlrev_b32 v13, 4, v13
    v_lshl_add_u32 v3, v12, 7, v13
    s_lshl_b32 s65, s4, 2
    s_add_u32 s65, s65, s3
    s_mul_i32 s65, s65, 81920
    s_add_u32 s65, s65, s14
    buffer_load_dwordx4 a[20:23], v62, s[8:11], s97 offen offset:1024 sc1
    s_and_b32 s66, s5, 3
    s_add_u32 s72, s66, 0
    s_and_b32 s72, s72, 3
    s_mul_i32 s72, s72, 20480
    s_add_u32 s67, s72, s65
    s_add_u32 s72, s66, 1
    s_and_b32 s72, s72, 3
    s_mul_i32 s72, s72, 20480
    buffer_load_dwordx4 a[24:27], v62, s[8:11], s97 offen offset:2048 sc1
    s_add_u32 s68, s72, s65
    s_add_u32 s72, s66, 2
    s_and_b32 s72, s72, 3
    s_mul_i32 s72, s72, 20480
    s_add_u32 s69, s72, s65
    s_add_u32 s72, s66, 3
    s_and_b32 s72, s72, 3
    s_mul_i32 s72, s72, 20480
    buffer_load_dwordx4 a[28:31], v62, s[8:11], s97 offen offset:3072 sc1
    s_add_u32 s70, s72, s65
    v_bfe_u32 v10, v1, 2, 2
    v_lshrrev_b32 v11, 4, v1
    v_lshl_add_u32 v10, v11, 2, v10
    v_and_b32 v11, 3, v1
    v_mul_u32_u24 v8, 96, v10
    v_lshl_add_u32 v8, v11, 3, v8
    s_and_b32 s72, s5, 1
    s_add_u32 s97, s96, 8192
    buffer_load_dwordx4 a[32:35], v62, s[8:11], s97 offen offset:0 sc1
    s_lshl_b32 s73, s72, 5
    s_xor_b32 s72, s72, 1
    s_lshl_b32 s72, s72, 6
    v_add_u32 v9, s72, v8
    v_add_u32 v8, s73, v8
    s_add_u32 s72, s66, 0
    s_and_b32 s72, s72, 3
    s_mul_i32 s82, s72, 15360
    buffer_load_dwordx4 a[36:39], v62, s[8:11], s97 offen offset:1024 sc1
    s_add_u32 s72, s66, 1
    s_and_b32 s72, s72, 3
    s_mul_i32 s83, s72, 15360
    s_add_u32 s72, s66, 2
    s_and_b32 s72, s72, 3
    s_mul_i32 s84, s72, 15360
    s_add_u32 s72, s66, 3
    s_and_b32 s72, s72, 3
    buffer_load_dwordx4 a[40:43], v62, s[8:11], s97 offen offset:2048 sc1
    s_mul_i32 s85, s72, 15360
    v_add_u32 v22, 61440, v8
    v_add_u32 v23, 61440, v9
    s_lshl_b32 s74, s4, 4
    s_lshl_b32 s75, s3, 2
    s_add_u32 s74, s74, s75
    s_mul_i32 s73, s74, 49152
    s_lshl_b32 s74, s74, 9
    buffer_load_dwordx4 a[44:47], v62, s[8:11], s97 offen offset:3072 sc1
    s_add_u32 s74, s74, s42
    s_lshr_b32 s72, s5, 1
    s_mul_i32 s72, s72, 3072
    s_add_u32 s73, s73, s72
    s_add_u32 s73, s73, s15
    s_lshr_b32 s75, s5, 3
    s_xor_b32 s76, s75, 1
    s_lshl_b32 s72, s76, 9
    s_add_u32 s45, s72, s74
    s_mul_i32 s76, s76, 49152
    s_add_u32 s52, s76, s73
    s_xor_b32 s76, s75, 2
    s_lshl_b32 s72, s76, 9
    s_add_u32 s46, s72, s74
    s_mul_i32 s76, s76, 49152
    s_add_u32 s53, s76, s73
    s_xor_b32 s76, s75, 3
    s_lshl_b32 s72, s76, 9
    s_add_u32 s47, s72, s74
    s_mul_i32 s76, s76, 49152
    s_add_u32 s54, s76, s73
    s_xor_b32 s76, s75, 0
    s_lshl_b32 s72, s76, 9
    s_add_u32 s48, s72, s74
    s_mul_i32 s76, s76, 49152
    s_add_u32 s55, s76, s73
    s_bfe_u32 s77, s5, 0x10002
    s_lshl_b32 s77, s77, 4
    s_add_u32 s44, s45, s77
    s_lshl_b32 s77, s66, 2
    s_add_u32 s44, s44, s77
    v_and_b32 v24, 15, v1
    v_lshlrev_b32 v24, 5, v24
    v_lshrrev_b32 v26, 4, v1
    v_lshlrev_b32 v26, 4, v26
    s_lshl_b32 s76, s2, 9
    s_add_u32 s76, s76, 0xea4000
    s_and_b32 s77, s5, 1
    s_lshl_b32 s56, s77, 11
    s_lshl_b32 s78, s77, 7
    s_add_u32 s49, s78, s76
    s_lshl_b32 s78, s77, 3
    v_lshl_add_u32 v21, v1, 4, s78
    v_lshlrev_b32 v20, 4, v1
    s_xor_b32 s77, s77, 1
    s_lshl_b32 s77, s77, 8
    s_add_u32 s50, s77, s76
    s_lshl_b32 s76, s4, 2
    s_add_u32 s76, s76, s75
    s_mul_i32 s60, s76, 196608
    s_mul_i32 s76, s76, 81920
    s_and_b32 s77, s5, 7
    s_mul_i32 s77, s77, 10240
    s_add_u32 s43, s76, s77
    s_lshl_b32 s76, s3, 12
    s_add_u32 s77, s76, 12288
    s_sub_u32 s76, s76, 8192
    s_cmp_ge_u32 s3, 2
    s_cselect_b32 s51, s76, s77
    s_add_u32 s65, s43, s14
    s_add_u32 s42, s43, 7854080
    s_mov_b32 s86, 0x22222222
    s_mov_b32 s87, s86
    s_mov_b32 s88, 0x44444444
    s_mov_b32 s89, s88
    s_mov_b32 s90, 0x88888888
    s_mov_b32 s91, s90
    s_mul_i32 s76, s3, 12288
    s_add_u32 s60, s60, s76
    s_add_u32 s76, s60, s15
    s_xor_b32 s77, s3, 1
    s_mul_i32 s77, s77, 49152
    s_add_u32 s60, s77, s76
    s_xor_b32 s77, s3, 2
    s_mul_i32 s77, s77, 49152
    s_add_u32 s61, s77, s76
    s_xor_b32 s77, s3, 3
    s_mul_i32 s77, s77, 49152
    s_add_u32 s62, s77, s76
    s_xor_b32 s77, s3, 0
    s_mul_i32 s77, s77, 49152
    s_add_u32 s63, s77, s76
    s_lshl_b32 s76, s4, 10
    s_add_u32 s76, s76, 0xec6000
    s_lshl_b32 s77, s75, 7
    s_add_u32 s57, s76, s77
    s_lshl_b32 s77, s3, 5
    s_add_u32 s57, s57, s77
    s_lshl_b32 s77, s3, 7
    s_add_u32 s58, s76, s77
    s_lshl_b32 s77, s5, 2
    s_add_u32 s58, s58, s77
    s_mov_b32 s92, s6
    v_lshrrev_b32 v27, 4, v1
    s_mov_b32 s76, 49152
    v_mul_lo_u32 v27, v27, s76
    v_and_b32 v12, 7, v1
    v_lshl_add_u32 v27, v12, 7, v27
    v_bfe_u32 v12, v1, 3, 1
    s_sub_u32 s76, s56, 1024
    v_mul_lo_u32 v12, v12, s76
    v_add3_u32 v27, v27, v12, s73
    v_bfe_u32 v12, v10, 1, 2
    v_xor_b32 v12, s75, v12
    v_lshlrev_b32 v12, 1, v12
    v_lshrrev_b32 v13, 1, v11
    v_and_b32 v14, 1, v11
    v_lshlrev_b32 v14, 3, v14
    v_lshl_add_u32 v14, v10, 7, v14
    v_add_u32 v14, s64, v14
    v_add_u32 v15, 2, v13
    v_xor_b32 v15, v15, v12
    v_lshl_add_u32 v4, v15, 4, v14
    v_add_u32 v15, 4, v13
    v_xor_b32 v15, v15, v12
    v_lshl_add_u32 v5, v15, 4, v14
    v_add_u32 v15, 6, v13
    v_xor_b32 v15, v15, v12
    v_lshl_add_u32 v6, v15, 4, v14
    v_add_u32 v15, 0, v13
    v_xor_b32 v15, v15, v12
    v_lshl_add_u32 v7, v15, 4, v14
    s_mov_b32 s72, 0x3f803f80
    v_mov_b32 v188, s72
    v_mov_b32 v189, s72
    v_mov_b32 v190, s72
    v_mov_b32 v191, s72
    s_lshl_b32 s16, s4, 2
    s_lshr_b32 s17, s5, 3
    s_add_u32 s16, s16, s17
    s_and_b32 s19, s5, 7
    s_xor_b32 s21, s3, 1
    s_mul_i32 s21, s21, 5120
    s_add_u32 s21, s21, 122880
    s_mov_b32 s26, s21
    s_xor_b32 s21, s3, 2
    s_mul_i32 s21, s21, 5120
    s_add_u32 s21, s21, 143360
    s_mov_b32 s27, s21
    s_xor_b32 s21, s3, 3
    s_mul_i32 s21, s21, 5120
    s_add_u32 s21, s21, 122880
    s_mov_b32 s28, s21
    s_mul_i32 s21, s3, 5120
    s_add_u32 s21, s21, 122880
    s_mov_b32 s29, s21
    v_and_b32 v36, 15, v1
    v_lshrrev_b32 v37, 4, v1
    v_lshrrev_b32 v38, 1, v37
    s_lshl_b32 s21, s3, 1
    v_add_u32 v38, s21, v38
    v_and_b32 v39, 7, v36
    v_xor_b32 v38, v38, v39
    v_lshlrev_b32 v38, 4, v38
    v_and_b32 v39, 1, v37
    v_lshl_add_u32 v38, v39, 3, v38
    v_lshl_add_u32 v38, v36, 7, v38
    v_add_u32 v40, 122880, v38
    v_bfe_u32 v39, v36, 3, 1
    v_mul_u32_u24 v39, 3072, v39
    v_add_u32 v41, v40, v39
    s_lshl_b32 s20, s16, 2
    s_add_u32 s20, s20, s3
    s_lshl_b32 s20, s20, 10
    s_add_u32 s20, s20, 0xe84000
    s_lshl_b32 s22, s19, 5
    s_add_u32 s22, s22, s20
    v_bfe_u32 v42, v1, 2, 2
    v_lshlrev_b32 v42, 3, v42
    v_lshl_add_u32 v42, v37, 8, v42
    v_and_b32 v43, 7, v1
    v_lshlrev_b32 v43, 5, v43
    v_bfe_u32 v39, v1, 3, 1
    v_lshl_add_u32 v43, v39, 4, v43
    v_lshl_add_u32 v43, v37, 8, v43
    s_mul_i32 s18, s3, 5120
    s_add_u32 s18, s18, 143360
    v_lshlrev_b32 v44, 5, v36
    v_lshl_add_u32 v44, v37, 3, v44
    v_add_u32 v44, s18, v44
    v_bfe_u32 v45, v1, 2, 2
    v_and_b32 v39, 3, v1
    v_lshl_add_u32 v45, v37, 3, v45
    v_lshlrev_b32 v45, 5, v45
    v_lshl_add_u32 v45, v39, 3, v45
    v_add_u32 v45, s18, v45
    s_mov_b32 s21, 0xffff0000
    v_accvgpr_write_b32 a250, v40
    v_accvgpr_write_b32 a251, v41
    v_accvgpr_write_b32 a252, v42
    v_accvgpr_write_b32 a253, v43
    v_accvgpr_write_b32 a254, v44
    v_accvgpr_write_b32 a255, v45
    v_accvgpr_write_b32 a240, v2
    v_accvgpr_write_b32 a241, v4
    v_accvgpr_write_b32 a242, v5
    v_accvgpr_write_b32 a243, v6
    v_accvgpr_write_b32 a244, v7
    v_accvgpr_write_b32 a245, v8
    v_accvgpr_write_b32 a246, v9
    v_accvgpr_write_b32 a247, v21
    v_accvgpr_write_b32 a248, v24
    v_accvgpr_write_b32 a249, v26
    v_add_u32 v16, s82, v8
    v_add_u32 v17, s82, v9
    v_add_u32 v18, s82, v22
    v_add_u32 v19, s82, v23
    v_bfe_u32 v60, v1, 2, 2
    v_lshrrev_b32 v61, 4, v1
    v_lshl_add_u32 v60, v61, 2, v60
    v_mul_u32_u24 v60, 160, v60
    v_and_b32 v61, 3, v1
    v_lshl_add_u32 v60, v61, 3, v60
    v_add_u32 v60, s94, v60
    s_waitcnt vmcnt(12)
    ds_read_b64_tr_b16 v[116:117], v60 offset:0
    ds_read_b64_tr_b16 v[118:119], v60 offset:32
    ds_read_b64_tr_b16 v[120:121], v60 offset:64
    ds_read_b64_tr_b16 v[122:123], v60 offset:96
    ds_read_b64_tr_b16 v[124:125], v60 offset:128
    s_waitcnt lgkmcnt(0)
    v_lshlrev_b32 v76, 16, v116
    v_and_b32 v77, s21, v116
    v_lshlrev_b32 v78, 16, v117
    v_and_b32 v79, s21, v117
    v_lshlrev_b32 v80, 16, v118
    v_and_b32 v81, s21, v118
    v_lshlrev_b32 v82, 16, v119
    v_and_b32 v83, s21, v119
    v_lshlrev_b32 v84, 16, v120
    v_and_b32 v85, s21, v120
    v_lshlrev_b32 v86, 16, v121
    v_and_b32 v87, s21, v121
    v_lshlrev_b32 v88, 16, v122
    v_and_b32 v89, s21, v122
    v_lshlrev_b32 v90, 16, v123
    v_and_b32 v91, s21, v123
    v_lshlrev_b32 v92, 16, v124
    v_and_b32 v93, s21, v124
    v_lshlrev_b32 v94, 16, v125
    v_and_b32 v95, s21, v125
    v_pk_fma_f32 v[96:97], v[76:77], v[64:65], v[68:69]
    v_pk_fma_f32 v[98:99], v[78:79], v[66:67], v[70:71]
    v_pk_fma_f32 v[100:101], v[80:81], v[64:65], v[68:69]
    v_pk_fma_f32 v[102:103], v[82:83], v[66:67], v[70:71]
    v_pk_fma_f32 v[104:105], v[84:85], v[64:65], v[68:69]
    v_pk_fma_f32 v[106:107], v[86:87], v[66:67], v[70:71]
    v_pk_fma_f32 v[108:109], v[88:89], v[64:65], v[68:69]
    v_pk_fma_f32 v[110:111], v[90:91], v[66:67], v[70:71]
    v_pk_fma_f32 v[112:113], v[92:93], v[64:65], v[68:69]
    v_pk_fma_f32 v[114:115], v[94:95], v[66:67], v[70:71]
    s_lshl_b32 s76, s3, 10
    s_add_u32 s95, s76, 122880
    s_add_u32 s76, s76, s43
    s_add_u32 s23, s76, 7864320
    s_add_u32 s24, s76, 5242880
    s_add_u32 s25, s95, 20480
    v_add_u32 v10, s25, v20
    s_mov_b32 s30, s24
    s_mov_b32 s31, s25
    s_lshl_b32 s93, s4, 9
    s_add_u32 s93, s93, 0xec8000
    s_add_u32 s97, s96, 12288
    buffer_load_dwordx4 a[48:51], v62, s[8:11], s97 offen offset:0 sc1
    buffer_load_dwordx4 a[52:55], v62, s[8:11], s97 offen offset:1024 sc1
    buffer_load_dwordx4 a[56:59], v62, s[8:11], s97 offen offset:2048 sc1
    buffer_load_dwordx4 a[60:63], v62, s[8:11], s97 offen offset:3072 sc1
    s_add_u32 s97, s96, 16384
    buffer_load_dwordx4 a[64:67], v62, s[8:11], s97 offen offset:0 sc1
    buffer_load_dwordx4 a[68:71], v62, s[8:11], s97 offen offset:1024 sc1
    buffer_load_dwordx4 a[72:75], v62, s[8:11], s97 offen offset:2048 sc1
    buffer_load_dwordx4 a[76:79], v62, s[8:11], s97 offen offset:3072 sc1
    s_add_u32 s97, s96, 20480
    buffer_load_dwordx4 a[80:83], v62, s[8:11], s97 offen offset:0 sc1
    buffer_load_dwordx4 a[84:87], v62, s[8:11], s97 offen offset:1024 sc1
    buffer_load_dwordx4 a[88:91], v62, s[8:11], s97 offen offset:2048 sc1
    buffer_load_dwordx4 a[92:95], v62, s[8:11], s97 offen offset:3072 sc1
    s_cmp_eq_u32 s3, 3
    s_cbranch_scc1 L_nob
    s_add_u32 s97, s96, 24576
    buffer_load_dwordx4 a[96:99], v62, s[8:11], s97 offen offset:0 sc1
    buffer_load_dwordx4 a[100:103], v62, s[8:11], s97 offen offset:1024 sc1
    buffer_load_dwordx4 a[104:107], v62, s[8:11], s97 offen offset:2048 sc1
    buffer_load_dwordx4 a[108:111], v62, s[8:11], s97 offen offset:3072 sc1
    s_add_u32 s97, s96, 28672
    buffer_load_dwordx4 a[112:115], v62, s[8:11], s97 offen offset:0 sc1
    buffer_load_dwordx4 a[116:119], v62, s[8:11], s97 offen offset:1024 sc1
    buffer_load_dwordx4 a[120:123], v62, s[8:11], s97 offen offset:2048 sc1
    buffer_load_dwordx4 a[124:127], v62, s[8:11], s97 offen offset:3072 sc1
    s_add_u32 s97, s96, 32768
    buffer_load_dwordx4 a[128:131], v62, s[8:11], s97 offen offset:0 sc1
    buffer_load_dwordx4 a[132:135], v62, s[8:11], s97 offen offset:1024 sc1
    buffer_load_dwordx4 a[136:139], v62, s[8:11], s97 offen offset:2048 sc1
    buffer_load_dwordx4 a[140:143], v62, s[8:11], s97 offen offset:3072 sc1
    s_add_u32 s97, s96, 36864
    buffer_load_dwordx4 a[144:147], v62, s[8:11], s97 offen offset:0 sc1
    buffer_load_dwordx4 a[148:151], v62, s[8:11], s97 offen offset:1024 sc1
    buffer_load_dwordx4 a[152:155], v62, s[8:11], s97 offen offset:2048 sc1
    buffer_load_dwordx4 a[156:159], v62, s[8:11], s97 offen offset:3072 sc1
    s_add_u32 s97, s96, 40960
    buffer_load_dwordx4 a[160:163], v62, s[8:11], s97 offen offset:0 sc1
    buffer_load_dwordx4 a[164:167], v62, s[8:11], s97 offen offset:1024 sc1
    buffer_load_dwordx4 a[168:171], v62, s[8:11], s97 offen offset:2048 sc1
    buffer_load_dwordx4 a[172:175], v62, s[8:11], s97 offen offset:3072 sc1
    s_add_u32 s97, s96, 45056
    buffer_load_dwordx4 a[176:179], v62, s[8:11], s97 offen offset:0 sc1
    buffer_load_dwordx4 a[180:183], v62, s[8:11], s97 offen offset:1024 sc1
    buffer_load_dwordx4 a[184:187], v62, s[8:11], s97 offen offset:2048 sc1
    buffer_load_dwordx4 a[188:191], v62, s[8:11], s97 offen offset:3072 sc1
L_nob:
    s_cmp_lg_u32 s5, 31
    s_cbranch_scc1 L_nl0
    s_cmp_lg_u32 s3, 0
    s_cbranch_scc1 L_nl0
    v_min_u32 v32, 26, v1
    v_lshlrev_b32 v32, 2, v32
    s_lshl_b32 s77, s4, 9
    s_add_u32 s77, s77, 0xec4000
    s_mov_b32 s79, 0
Lpoll_33:
    buffer_load_dword v33, v32, s[8:11], s77 offen sc1
    s_waitcnt vmcnt(0)
    v_subrev_u32 v33, s6, v33
    v_and_b32 v34, -9, v33
    v_subrev_u32 v34, 3, v34
    v_cmp_le_u32 vcc, 6, v34
    s_cbranch_vccz Lpd_34
    s_add_u32 s79, s79, 1
    s_cmp_lt_u32 s79, s80
    s_cbranch_scc1 Lpoll_33
    s_mov_b32 s80, 0
Lpd_34:
    s_add_u32 s78, s6, 1
    v_mov_b32 v34, s78
    v_lshlrev_b32 v33, 9, v1
    s_lshl_b32 s77, s4, 2
    s_add_u32 s77, s77, 0xec4100
    s_mov_b64 exec, 0xff
    buffer_store_dword v34, v33, s[8:11], s77 offen sc1
    s_mov_b64 exec, -1
L_nl0:
    s_cmp_lg_u32 s3, 3
    s_cbranch_scc1 L_s2b
    v_and_b32 v32, 7, v1
    v_lshlrev_b32 v32, 2, v32
    s_lshl_b32 s77, s4, 9
    s_add_u32 s77, s77, 0xec4100
    s_mov_b32 s79, 0
Lpoll_35:
    buffer_load_dword v33, v32, s[8:11], s77 offen sc1
    s_waitcnt vmcnt(0)
    v_cmp_ne_u32 vcc, v35, v33
    s_cbranch_vccz Lpd_36
    s_add_u32 s79, s79, 1
    s_cmp_lt_u32 s79, s80
    s_cbranch_scc1 Lpoll_35
    s_mov_b32 s80, 0
Lpd_36:
L_s2b:
    s_waitcnt vmcnt(0) lgkmcnt(0)
    s_barrier
    s_add_u32 m0, s95, 0
    s_add_u32 s76, s23, 0
    buffer_load_dwordx4 v3, s[8:11], s76 offen sc1 lds
    s_add_u32 m0, s95, 4096
    s_add_u32 s76, s23, 4096
    buffer_load_dwordx4 v3, s[8:11], s76 offen sc1 lds
    s_cmp_ge_u32 s3, 2
    s_cbranch_scc1 L_y2
    s_add_u32 m0, s95, 8192
    s_add_u32 s76, s23, 8192
    buffer_load_dwordx4 v3, s[8:11], s76 offen sc1 lds
L_y2:
    s_waitcnt vmcnt(0)
    s_barrier
    ds_read_b64 v[136:137], v40 offset:0
    ds_read_b64 v[138:139], v40 offset:2048
    ds_read_b64 v[140:141], v40 offset:4096
    ds_read_b64 v[142:143], v40 offset:6144
    ds_read_b64 v[144:145], v40 offset:8192
    s_waitcnt lgkmcnt(4)
    v_lshlrev_b32 v116, 16, v136
    v_and_b32 v117, s21, v136
    v_lshlrev_b32 v118, 16, v137
    v_and_b32 v119, s21, v137
    v_pk_fma_f32 v[76:77], v[96:97], v[116:117], v[76:77]
    v_pk_fma_f32 v[78:79], v[98:99], v[118:119], v[78:79]
    v_cvt_pk_bf16_f32 v96, v76, v77
    v_cvt_pk_bf16_f32 v97, v78, v79
    ds_write_b64 v40, v[96:97] offset:20480
    s_waitcnt lgkmcnt(4)
    v_lshlrev_b32 v116, 16, v138
    v_and_b32 v117, s21, v138
    v_lshlrev_b32 v118, 16, v139
    v_and_b32 v119, s21, v139
    v_pk_fma_f32 v[80:81], v[100:101], v[116:117], v[80:81]
    v_pk_fma_f32 v[82:83], v[102:103], v[118:119], v[82:83]
    v_cvt_pk_bf16_f32 v98, v80, v81
    v_cvt_pk_bf16_f32 v99, v82, v83
    ds_write_b64 v40, v[98:99] offset:22528
    s_waitcnt lgkmcnt(4)
    v_lshlrev_b32 v116, 16, v140
    v_and_b32 v117, s21, v140
    v_lshlrev_b32 v118, 16, v141
    v_and_b32 v119, s21, v141
    v_pk_fma_f32 v[84:85], v[104:105], v[116:117], v[84:85]
    v_pk_fma_f32 v[86:87], v[106:107], v[118:119], v[86:87]
    v_cvt_pk_bf16_f32 v100, v84, v85
    v_cvt_pk_bf16_f32 v101, v86, v87
    ds_write_b64 v40, v[100:101] offset:24576
    s_waitcnt lgkmcnt(4)
    v_lshlrev_b32 v116, 16, v142
    v_and_b32 v117, s21, v142
    v_lshlrev_b32 v118, 16, v143
    v_and_b32 v119, s21, v143
    v_pk_fma_f32 v[88:89], v[108:109], v[116:117], v[88:89]
    v_pk_fma_f32 v[90:91], v[110:111], v[118:119], v[90:91]
    v_cvt_pk_bf16_f32 v102, v88, v89
    v_cvt_pk_bf16_f32 v103, v90, v91
    ds_write_b64 v40, v[102:103] offset:26624
    s_waitcnt lgkmcnt(4)
    v_lshlrev_b32 v116, 16, v144
    v_and_b32 v117, s21, v144
    v_lshlrev_b32 v118, 16, v145
    v_and_b32 v119, s21, v145
    v_pk_fma_f32 v[92:93], v[112:113], v[116:117], v[92:93]
    v_pk_fma_f32 v[94:95], v[114:115], v[118:119], v[94:95]
    v_cvt_pk_bf16_f32 v104, v92, v93
    v_cvt_pk_bf16_f32 v105, v94, v95
    ds_write_b64 v40, v[104:105] offset:28672
    s_add_u32 s76, s24, 4096
    s_add_u32 s77, s24, 8192
    s_waitcnt lgkmcnt(0)
    s_barrier
    ds_read_b128 v[64:67], v10 offset:0
    ds_read_b128 v[68:71], v10 offset:4096
    ds_read_b128 v[72:75], v10 offset:8192
    s_waitcnt lgkmcnt(1)
    s_cmp_eq_u32 s12, 1
    s_cbranch_scc1 Lf_37
    buffer_store_dwordx4 v[64:67], v3, s[8:11], s24 offen sc1
    buffer_store_dwordx4 v[68:71], v3, s[8:11], s76 offen sc1
    s_branch Lg_38
Lf_37:
    buffer_store_dwordx4 v[64:67], v3, s[8:11], s24 offen
    buffer_store_dwordx4 v[68:71], v3, s[8:11], s76 offen
Lg_38:
    s_waitcnt lgkmcnt(0)
    s_cmp_ge_u32 s3, 2
    s_cbranch_scc1 L_x1d
    s_cmp_eq_u32 s12, 1
    s_cbranch_scc1 Lf_39
    buffer_store_dwordx4 v[72:75], v3, s[8:11], s77 offen sc1
    s_branch Lg_40
Lf_39:
    buffer_store_dwordx4 v[72:75], v3, s[8:11], s77 offen
Lg_40:
L_x1d:
    s_barrier
    s_lshl_b32 s76, s5, 4
    s_lshl_b32 s77, s3, 2
    s_add_u32 s76, s76, s77
    s_add_u32 s76, s76, s93
    s_add_u32 s77, s6, 1
    v_mov_b32 v32, s77
    v_mov_b32 v33, 0
    s_waitcnt vmcnt(0)
    s_mov_b64 exec, 1
    s_cmp_eq_u32 s12, 1
    s_cbranch_scc1 Lf_41
    buffer_store_dword v32, v33, s[8:11], s76 offen sc1
    s_branch Lg_42
Lf_41:
    buffer_store_dword v32, v33, s[8:11], s76 offen
Lg_42:
    s_mov_b64 exec, -1
    s_cmp_lg_u32 s3, 3
    s_cbranch_scc1 L_nob2
    s_add_u32 s97, s96, 24576
    buffer_load_dwordx4 a[96:99], v62, s[8:11], s97 offen offset:0 sc1
    buffer_load_dwordx4 a[100:103], v62, s[8:11], s97 offen offset:1024 sc1
    buffer_load_dwordx4 a[104:107], v62, s[8:11], s97 offen offset:2048 sc1
    buffer_load_dwordx4 a[108:111], v62, s[8:11], s97 offen offset:3072 sc1
    s_add_u32 s97, s96, 28672
    buffer_load_dwordx4 a[112:115], v62, s[8:11], s97 offen offset:0 sc1
    buffer_load_dwordx4 a[116:119], v62, s[8:11], s97 offen offset:1024 sc1
    buffer_load_dwordx4 a[120:123], v62, s[8:11], s97 offen offset:2048 sc1
    buffer_load_dwordx4 a[124:127], v62, s[8:11], s97 offen offset:3072 sc1
    s_add_u32 s97, s96, 32768
    buffer_load_dwordx4 a[128:131], v62, s[8:11], s97 offen offset:0 sc1
    buffer_load_dwordx4 a[132:135], v62, s[8:11], s97 offen offset:1024 sc1
    buffer_load_dwordx4 a[136:139], v62, s[8:11], s97 offen offset:2048 sc1
    buffer_load_dwordx4 a[140:143], v62, s[8:11], s97 offen offset:3072 sc1
    s_add_u32 s97, s96, 36864
    buffer_load_dwordx4 a[144:147], v62, s[8:11], s97 offen offset:0 sc1
    buffer_load_dwordx4 a[148:151], v62, s[8:11], s97 offen offset:1024 sc1
    buffer_load_dwordx4 a[152:155], v62, s[8:11], s97 offen offset:2048 sc1
    buffer_load_dwordx4 a[156:159], v62, s[8:11], s97 offen offset:3072 sc1
    s_add_u32 s97, s96, 40960
    buffer_load_dwordx4 a[160:163], v62, s[8:11], s97 offen offset:0 sc1
    buffer_load_dwordx4 a[164:167], v62, s[8:11], s97 offen offset:1024 sc1
    buffer_load_dwordx4 a[168:171], v62, s[8:11], s97 offen offset:2048 sc1
    buffer_load_dwordx4 a[172:175], v62, s[8:11], s97 offen offset:3072 sc1
    s_add_u32 s97, s96, 45056
    buffer_load_dwordx4 a[176:179], v62, s[8:11], s97 offen offset:0 sc1
    buffer_load_dwordx4 a[180:183], v62, s[8:11], s97 offen offset:1024 sc1
    buffer_load_dwordx4 a[184:187], v62, s[8:11], s97 offen offset:2048 sc1
    buffer_load_dwordx4 a[188:191], v62, s[8:11], s97 offen offset:3072 sc1
L_nob2:
    s_add_u32 s97, s96, 49152
    buffer_load_dwordx4 a[192:195], v62, s[8:11], s97 offen offset:0 sc1
    buffer_load_dwordx4 a[196:199], v62, s[8:11], s97 offen offset:1024 sc1
    buffer_load_dwordx4 a[200:203], v62, s[8:11], s97 offen offset:2048 sc1
    buffer_load_dwordx4 a[204:207], v62, s[8:11], s97 offen offset:3072 sc1
    s_add_u32 s97, s96, 53248
    buffer_load_dwordx4 a[208:211], v62, s[8:11], s97 offen offset:0 sc1
    buffer_load_dwordx4 a[212:215], v62, s[8:11], s97 offen offset:1024 sc1
    buffer_load_dwordx4 a[216:219], v62, s[8:11], s97 offen offset:2048 sc1
    buffer_load_dwordx4 a[220:223], v62, s[8:11], s97 offen offset:3072 sc1
    s_add_u32 s97, s96, 57344
    buffer_load_dwordx4 a[224:227], v62, s[8:11], s97 offen offset:0 sc1
    buffer_load_dwordx4 a[228:231], v62, s[8:11], s97 offen offset:1024 sc1
    buffer_load_dwordx4 a[232:235], v62, s[8:11], s97 offen offset:2048 sc1
    buffer_load_dwordx4 a[236:239], v62, s[8:11], s97 offen offset:3072 sc1
    s_add_u32 m0, s64, 0
    s_add_u32 s71, s67, 0
    v_and_b32 v32, 31, v1
    v_lshlrev_b32 v32, 2, v32
    s_lshl_b32 s76, s3, 7
    s_add_u32 s77, s93, s76
    s_add_u32 s76, s6, 1
    s_mov_b32 s79, 0
Lpoll_43:
    buffer_load_dword v33, v32, s[8:11], s77 offen sc1
    s_waitcnt vmcnt(0)
    v_cmp_ne_u32 vcc, s76, v33
    s_cbranch_vccz Lpd_44
    s_add_u32 s79, s79, 1
    s_cmp_lt_u32 s79, s80
    s_cbranch_scc1 Lpoll_43
    s_mov_b32 s80, 0
Lpd_44:
L_g1go:
    buffer_load_dwordx4 v2, s[8:11], s71 offen offset:0 sc1 lds
    buffer_load_dwordx4 v2, s[8:11], s71 offen offset:1024 sc1 lds
    buffer_load_dwordx4 v2, s[8:11], s71 offen offset:2048 sc1 lds
    buffer_load_dwordx4 v2, s[8:11], s71 offen offset:3072 sc1 lds
    s_add_u32 m0, s64, 4096
    s_add_u32 s71, s67, 4096
    buffer_load_dwordx4 v2, s[8:11], s71 offen offset:0 sc1 lds
    buffer_load_dwordx4 v2, s[8:11], s71 offen offset:1024 sc1 lds
    buffer_load_dwordx4 v2, s[8:11], s71 offen offset:2048 sc1 lds
    buffer_load_dwordx4 v2, s[8:11], s71 offen offset:3072 sc1 lds
    ds_read_b64_tr_b16 v[160:161], v16 offset:0
    ds_read_b64_tr_b16 v[162:163], v16 offset:1536
    ds_read_b64_tr_b16 v[164:165], v18 offset:0
    ds_read_b64_tr_b16 v[166:167], v18 offset:1536
    ds_read_b64_tr_b16 v[168:169], v16 offset:32
    ds_read_b64_tr_b16 v[170:171], v16 offset:1568
    ds_read_b64_tr_b16 v[172:173], v18 offset:32
    ds_read_b64_tr_b16 v[174:175], v18 offset:1568
    ds_read_b64_tr_b16 v[176:177], v17 offset:0
    ds_read_b64_tr_b16 v[178:179], v17 offset:1536
    s_add_u32 m0, s64, 0
    s_add_u32 s71, s67, 8192
    s_bfe_u32 vcc_lo, s5, 0x10002
    s_mov_b32 vcc_hi, 0
    s_waitcnt vmcnt(4)
    ds_read_b64_tr_b16 v[128:129], v4 offset:0
    ds_read_b64_tr_b16 v[130:131], v4 offset:2048
    ds_read_b64_tr_b16 v[132:133], v5 offset:0
    ds_read_b64_tr_b16 v[134:135], v5 offset:2048
    ds_read_b64_tr_b16 v[136:137], v6 offset:0
    ds_read_b64_tr_b16 v[138:139], v6 offset:2048
    ds_read_b64_tr_b16 v[140:141], v7 offset:0
    ds_read_b64_tr_b16 v[142:143], v7 offset:2048
    s_waitcnt lgkmcnt(0)
    v_mfma_f32_16x16x32_bf16 v[32:35], v[160:163], v[128:131], 0
    ds_read_b64_tr_b16 v[180:181], v19 offset:0
    v_mfma_f32_16x16x32_bf16 v[56:59], v[160:163], v[132:135], 0
    ds_read_b64_tr_b16 v[182:183], v19 offset:1536
    v_mfma_f32_16x16x32_bf16 v[80:83], v[160:163], v[136:139], 0
    buffer_load_dwordx4 v2, s[8:11], s71 offen offset:0 sc1 lds
    v_mfma_f32_16x16x32_bf16 v[104:107], v[160:163], v[140:143], 0
    buffer_load_dwordx4 v2, s[8:11], s71 offen offset:1024 sc1 lds
    v_mfma_f32_16x16x32_bf16 v[108:111], v[164:167], v[140:143], 0
    ds_read_b64_tr_b16 v[160:161], v16 offset:3072
    v_mfma_f32_16x16x32_bf16 v[84:87], v[164:167], v[136:139], 0
    ds_read_b64_tr_b16 v[162:163], v16 offset:4608
    v_mfma_f32_16x16x32_bf16 v[60:63], v[164:167], v[132:135], 0
    buffer_load_dwordx4 v2, s[8:11], s71 offen offset:2048 sc1 lds
    v_mfma_f32_16x16x32_bf16 v[36:39], v[164:167], v[128:131], 0
    buffer_load_dwordx4 v2, s[8:11], s71 offen offset:3072 sc1 lds
    v_mfma_f32_16x16x32_bf16 v[40:43], v[168:171], v[128:131], 0
    ds_read_b64_tr_b16 v[164:165], v18 offset:3072
    v_mfma_f32_16x16x32_bf16 v[64:67], v[168:171], v[132:135], 0
    ds_read_b64_tr_b16 v[166:167], v18 offset:4608
    v_mfma_f32_16x16x32_bf16 v[88:91], v[168:171], v[136:139], 0
    s_waitcnt vmcnt(4)
    ds_read_b64_tr_b16 v[144:145], v4 offset:4096
    v_mfma_f32_16x16x32_bf16 v[112:115], v[168:171], v[140:143], 0
    ds_read_b64_tr_b16 v[146:147], v4 offset:6144
    v_mfma_f32_16x16x32_bf16 v[116:119], v[172:175], v[140:143], 0
    ds_read_b64_tr_b16 v[168:169], v16 offset:3104
    ds_read_b64_tr_b16 v[148:149], v5 offset:4096
    v_mfma_f32_16x16x32_bf16 v[92:95], v[172:175], v[136:139], 0
    ds_read_b64_tr_b16 v[170:171], v16 offset:4640
    ds_read_b64_tr_b16 v[150:151], v5 offset:6144
    v_mfma_f32_16x16x32_bf16 v[68:71], v[172:175], v[132:135], 0
    ds_read_b64_tr_b16 v[152:153], v6 offset:4096
    v_mfma_f32_16x16x32_bf16 v[44:47], v[172:175], v[128:131], 0
    ds_read_b64_tr_b16 v[154:155], v6 offset:6144
    s_waitcnt lgkmcnt(12)
    v_mfma_f32_16x16x32_bf16 v[48:51], v[176:179], v[128:131], 0
    ds_read_b64_tr_b16 v[172:173], v18 offset:3104
    ds_read_b64_tr_b16 v[156:157], v7 offset:4096
    v_mfma_f32_16x16x32_bf16 v[72:75], v[176:179], v[132:135], 0
    ds_read_b64_tr_b16 v[174:175], v18 offset:4640
    ds_read_b64_tr_b16 v[158:159], v7 offset:6144
    v_mfma_f32_16x16x32_bf16 v[96:99], v[176:179], v[136:139], 0
    v_mfma_f32_16x16x32_bf16 v[120:123], v[176:179], v[140:143], 0
    s_cbranch_vccz Lsq_45
    v_mfma_f32_16x16x32_bf16 v[184:187], v[188:191], v[128:131], 0
    s_branch Lsd_46
Lsq_45:
    v_mfma_f32_16x16x32_bf16 v[184:187], v[128:131], v[128:131], 0
Lsd_46:
    v_mfma_f32_16x16x32_bf16 v[124:127], v[180:183], v[140:143], 0
    ds_read_b64_tr_b16 v[176:177], v17 offset:3072
    v_mfma_f32_16x16x32_bf16 v[100:103], v[180:183], v[136:139], 0
    ds_read_b64_tr_b16 v[178:179], v17 offset:4608
    v_mfma_f32_16x16x32_bf16 v[76:79], v[180:183], v[132:135], 0
    s_add_u32 m0, s64, 4096
    v_mfma_f32_16x16x32_bf16 v[52:55], v[180:183], v[128:131], 0
    s_add_u32 s71, s67, 12288
    s_waitcnt lgkmcnt(2)
    v_mfma_f32_16x16x32_bf16 v[32:35], v[160:163], v[144:147], v[32:35]
    ds_read_b64_tr_b16 v[180:181], v19 offset:3072
    v_mfma_f32_16x16x32_bf16 v[56:59], v[160:163], v[148:151], v[56:59]
    ds_read_b64_tr_b16 v[182:183], v19 offset:4608
    v_mfma_f32_16x16x32_bf16 v[80:83], v[160:163], v[152:155], v[80:83]
    buffer_load_dwordx4 v2, s[8:11], s71 offen offset:0 sc1 lds
    v_mfma_f32_16x16x32_bf16 v[104:107], v[160:163], v[156:159], v[104:107]
    buffer_load_dwordx4 v2, s[8:11], s71 offen offset:1024 sc1 lds
    v_mfma_f32_16x16x32_bf16 v[108:111], v[164:167], v[156:159], v[108:111]
    ds_read_b64_tr_b16 v[160:161], v16 offset:6144
    v_mfma_f32_16x16x32_bf16 v[84:87], v[164:167], v[152:155], v[84:87]
    ds_read_b64_tr_b16 v[162:163], v16 offset:7680
    v_mfma_f32_16x16x32_bf16 v[60:63], v[164:167], v[148:151], v[60:63]
    buffer_load_dwordx4 v2, s[8:11], s71 offen offset:2048 sc1 lds
    v_mfma_f32_16x16x32_bf16 v[36:39], v[164:167], v[144:147], v[36:39]
    buffer_load_dwordx4 v2, s[8:11], s71 offen offset:3072 sc1 lds
    v_mfma_f32_16x16x32_bf16 v[40:43], v[168:171], v[144:147], v[40:43]
    ds_read_b64_tr_b16 v[164:165], v18 offset:6144
    v_mfma_f32_16x16x32_bf16 v[64:67], v[168:171], v[148:151], v[64:67]
    ds_read_b64_tr_b16 v[166:167], v18 offset:7680
    v_mfma_f32_16x16x32_bf16 v[88:91], v[168:171], v[152:155], v[88:91]
    s_waitcnt vmcnt(4)
    ds_read_b64_tr_b16 v[128:129], v4 offset:0
    v_mfma_f32_16x16x32_bf16 v[112:115], v[168:171], v[156:159], v[112:115]
    ds_read_b64_tr_b16 v[130:131], v4 offset:2048
    v_mfma_f32_16x16x32_bf16 v[116:119], v[172:175], v[156:159], v[116:119]
    ds_read_b64_tr_b16 v[168:169], v16 offset:6176
    ds_read_b64_tr_b16 v[132:133], v5 offset:0
    v_mfma_f32_16x16x32_bf16 v[92:95], v[172:175], v[152:155], v[92:95]
    ds_read_b64_tr_b16 v[170:171], v16 offset:7712
    ds_read_b64_tr_b16 v[134:135], v5 offset:2048
    v_mfma_f32_16x16x32_bf16 v[68:71], v[172:175], v[148:151], v[68:71]
    ds_read_b64_tr_b16 v[136:137], v6 offset:0
    v_mfma_f32_16x16x32_bf16 v[44:47], v[172:175], v[144:147], v[44:47]
    ds_read_b64_tr_b16 v[138:139], v6 offset:2048
    s_waitcnt lgkmcnt(12)
    v_mfma_f32_16x16x32_bf16 v[48:51], v[176:179], v[144:147], v[48:51]
    ds_read_b64_tr_b16 v[172:173], v18 offset:6176
    ds_read_b64_tr_b16 v[140:141], v7 offset:0
    v_mfma_f32_16x16x32_bf16 v[72:75], v[176:179], v[148:151], v[72:75]
    ds_read_b64_tr_b16 v[174:175], v18 offset:7712
    ds_read_b64_tr_b16 v[142:143], v7 offset:2048
    v_mfma_f32_16x16x32_bf16 v[96:99], v[176:179], v[152:155], v[96:99]
    v_mfma_f32_16x16x32_bf16 v[120:123], v[176:179], v[156:159], v[120:123]
    s_cbranch_vccz Lsq_47
    v_mfma_f32_16x16x32_bf16 v[184:187], v[188:191], v[144:147], v[184:187]
    s_branch Lsd_48
Lsq_47:
    v_mfma_f32_16x16x32_bf16 v[184:187], v[144:147], v[144:147], v[184:187]
Lsd_48:
    v_mfma_f32_16x16x32_bf16 v[124:127], v[180:183], v[156:159], v[124:127]
    ds_read_b64_tr_b16 v[176:177], v17 offset:6144
    v_mfma_f32_16x16x32_bf16 v[100:103], v[180:183], v[152:155], v[100:103]
    ds_read_b64_tr_b16 v[178:179], v17 offset:7680
    v_mfma_f32_16x16x32_bf16 v[76:79], v[180:183], v[148:151], v[76:79]
    s_add_u32 m0, s64, 0
    v_mfma_f32_16x16x32_bf16 v[52:55], v[180:183], v[144:147], v[52:55]
    s_add_u32 s71, s67, 16384
    s_waitcnt lgkmcnt(2)
    v_mfma_f32_16x16x32_bf16 v[32:35], v[160:163], v[128:131], v[32:35]
    ds_read_b64_tr_b16 v[180:181], v19 offset:6144
    v_mfma_f32_16x16x32_bf16 v[56:59], v[160:163], v[132:135], v[56:59]
    ds_read_b64_tr_b16 v[182:183], v19 offset:7680
    v_mfma_f32_16x16x32_bf16 v[80:83], v[160:163], v[136:139], v[80:83]
    buffer_load_dwordx4 v2, s[8:11], s71 offen offset:0 sc1 lds
    v_mfma_f32_16x16x32_bf16 v[104:107], v[160:163], v[140:143], v[104:107]
    buffer_load_dwordx4 v2, s[8:11], s71 offen offset:1024 sc1 lds
    v_mfma_f32_16x16x32_bf16 v[108:111], v[164:167], v[140:143], v[108:111]
    ds_read_b64_tr_b16 v[160:161], v16 offset:9216
    v_mfma_f32_16x16x32_bf16 v[84:87], v[164:167], v[136:139], v[84:87]
    ds_read_b64_tr_b16 v[162:163], v16 offset:10752
    v_mfma_f32_16x16x32_bf16 v[60:63], v[164:167], v[132:135], v[60:63]
    buffer_load_dwordx4 v2, s[8:11], s71 offen offset:2048 sc1 lds
    v_mfma_f32_16x16x32_bf16 v[36:39], v[164:167], v[128:131], v[36:39]
    buffer_load_dwordx4 v2, s[8:11], s71 offen offset:3072 sc1 lds
    v_mfma_f32_16x16x32_bf16 v[40:43], v[168:171], v[128:131], v[40:43]
    ds_read_b64_tr_b16 v[164:165], v18 offset:9216
    v_mfma_f32_16x16x32_bf16 v[64:67], v[168:171], v[132:135], v[64:67]
    ds_read_b64_tr_b16 v[166:167], v18 offset:10752
    v_mfma_f32_16x16x32_bf16 v[88:91], v[168:171], v[136:139], v[88:91]
    s_waitcnt vmcnt(4)
    ds_read_b64_tr_b16 v[144:145], v4 offset:4096
    v_mfma_f32_16x16x32_bf16 v[112:115], v[168:171], v[140:143], v[112:115]
    ds_read_b64_tr_b16 v[146:147], v4 offset:6144
    v_mfma_f32_16x16x32_bf16 v[116:119], v[172:175], v[140:143], v[116:119]
    ds_read_b64_tr_b16 v[168:169], v16 offset:9248
    ds_read_b64_tr_b16 v[148:149], v5 offset:4096
    v_mfma_f32_16x16x32_bf16 v[92:95], v[172:175], v[136:139], v[92:95]
    ds_read_b64_tr_b16 v[170:171], v16 offset:10784
    ds_read_b64_tr_b16 v[150:151], v5 offset:6144
    v_mfma_f32_16x16x32_bf16 v[68:71], v[172:175], v[132:135], v[68:71]
    ds_read_b64_tr_b16 v[152:153], v6 offset:4096
    v_mfma_f32_16x16x32_bf16 v[44:47], v[172:175], v[128:131], v[44:47]
    ds_read_b64_tr_b16 v[154:155], v6 offset:6144
    s_waitcnt lgkmcnt(12)
    v_mfma_f32_16x16x32_bf16 v[48:51], v[176:179], v[128:131], v[48:51]
    ds_read_b64_tr_b16 v[172:173], v18 offset:9248
    ds_read_b64_tr_b16 v[156:157], v7 offset:4096
    v_mfma_f32_16x16x32_bf16 v[72:75], v[176:179], v[132:135], v[72:75]
    ds_read_b64_tr_b16 v[174:175], v18 offset:10784
    ds_read_b64_tr_b16 v[158:159], v7 offset:6144
    v_mfma_f32_16x16x32_bf16 v[96:99], v[176:179], v[136:139], v[96:99]
    v_add_u32 v28, s83, v8
    v_mfma_f32_16x16x32_bf16 v[120:123], v[176:179], v[140:143], v[120:123]
    s_cbranch_vccz Lsq_49
    v_mfma_f32_16x16x32_bf16 v[184:187], v[188:191], v[128:131], v[184:187]
    s_branch Lsd_50
Lsq_49:
    v_mfma_f32_16x16x32_bf16 v[184:187], v[128:131], v[128:131], v[184:187]
Lsd_50:
    v_add_u32 v29, s83, v9
    v_mfma_f32_16x16x32_bf16 v[124:127], v[180:183], v[140:143], v[124:127]
    ds_read_b64_tr_b16 v[176:177], v17 offset:9216
    v_mfma_f32_16x16x32_bf16 v[100:103], v[180:183], v[136:139], v[100:103]
    ds_read_b64_tr_b16 v[178:179], v17 offset:10752
    v_mfma_f32_16x16x32_bf16 v[76:79], v[180:183], v[132:135], v[76:79]
    s_add_u32 m0, s64, 4096
    v_add_u32 v30, s83, v22
    v_mfma_f32_16x16x32_bf16 v[52:55], v[180:183], v[128:131], v[52:55]
    s_add_u32 s71, s68, 0
    v_add_u32 v31, s83, v23
    s_waitcnt lgkmcnt(2)
    v_mfma_f32_16x16x32_bf16 v[32:35], v[160:163], v[144:147], v[32:35]
    ds_read_b64_tr_b16 v[180:181], v19 offset:9216
    v_mfma_f32_16x16x32_bf16 v[56:59], v[160:163], v[148:151], v[56:59]
    ds_read_b64_tr_b16 v[182:183], v19 offset:10752
    v_mfma_f32_16x16x32_bf16 v[80:83], v[160:163], v[152:155], v[80:83]
    buffer_load_dwordx4 v2, s[8:11], s71 offen offset:0 sc1 lds
    v_mfma_f32_16x16x32_bf16 v[104:107], v[160:163], v[156:159], v[104:107]
    buffer_load_dwordx4 v2, s[8:11], s71 offen offset:1024 sc1 lds
    v_mfma_f32_16x16x32_bf16 v[108:111], v[164:167], v[156:159], v[108:111]
    ds_read_b64_tr_b16 v[160:161], v16 offset:12288
    v_mfma_f32_16x16x32_bf16 v[84:87], v[164:167], v[152:155], v[84:87]
    ds_read_b64_tr_b16 v[162:163], v16 offset:13824
    v_mfma_f32_16x16x32_bf16 v[60:63], v[164:167], v[148:151], v[60:63]
    buffer_load_dwordx4 v2, s[8:11], s71 offen offset:2048 sc1 lds
    v_mfma_f32_16x16x32_bf16 v[36:39], v[164:167], v[144:147], v[36:39]
    buffer_load_dwordx4 v2, s[8:11], s71 offen offset:3072 sc1 lds
    v_mfma_f32_16x16x32_bf16 v[40:43], v[168:171], v[144:147], v[40:43]
    ds_read_b64_tr_b16 v[164:165], v18 offset:12288
    v_mfma_f32_16x16x32_bf16 v[64:67], v[168:171], v[148:151], v[64:67]
    ds_read_b64_tr_b16 v[166:167], v18 offset:13824
    v_mfma_f32_16x16x32_bf16 v[88:91], v[168:171], v[152:155], v[88:91]
    s_waitcnt vmcnt(4)
    ds_read_b64_tr_b16 v[128:129], v4 offset:0
    v_mfma_f32_16x16x32_bf16 v[112:115], v[168:171], v[156:159], v[112:115]
    ds_read_b64_tr_b16 v[130:131], v4 offset:2048
    v_mfma_f32_16x16x32_bf16 v[116:119], v[172:175], v[156:159], v[116:119]
    ds_read_b64_tr_b16 v[168:169], v16 offset:12320
    ds_read_b64_tr_b16 v[132:133], v5 offset:0
    v_mfma_f32_16x16x32_bf16 v[92:95], v[172:175], v[152:155], v[92:95]
    ds_read_b64_tr_b16 v[170:171], v16 offset:13856
    ds_read_b64_tr_b16 v[134:135], v5 offset:2048
    v_mfma_f32_16x16x32_bf16 v[68:71], v[172:175], v[148:151], v[68:71]
    ds_read_b64_tr_b16 v[136:137], v6 offset:0
    v_mfma_f32_16x16x32_bf16 v[44:47], v[172:175], v[144:147], v[44:47]
    ds_read_b64_tr_b16 v[138:139], v6 offset:2048
    s_waitcnt lgkmcnt(12)
    v_mfma_f32_16x16x32_bf16 v[48:51], v[176:179], v[144:147], v[48:51]
    ds_read_b64_tr_b16 v[172:173], v18 offset:12320
    ds_read_b64_tr_b16 v[140:141], v7 offset:0
    v_mfma_f32_16x16x32_bf16 v[72:75], v[176:179], v[148:151], v[72:75]
    ds_read_b64_tr_b16 v[174:175], v18 offset:13856
    ds_read_b64_tr_b16 v[142:143], v7 offset:2048
    v_mfma_f32_16x16x32_bf16 v[96:99], v[176:179], v[152:155], v[96:99]
    v_mfma_f32_16x16x32_bf16 v[120:123], v[176:179], v[156:159], v[120:123]
    s_cbranch_vccz Lsq_51
    v_mfma_f32_16x16x32_bf16 v[184:187], v[188:191], v[144:147], v[184:187]
    s_branch Lsd_52
Lsq_51:
    v_mfma_f32_16x16x32_bf16 v[184:187], v[144:147], v[144:147], v[184:187]
Lsd_52:
    v_mfma_f32_16x16x32_bf16 v[124:127], v[180:183], v[156:159], v[124:127]
    ds_read_b64_tr_b16 v[176:177], v17 offset:12288
    v_mfma_f32_16x16x32_bf16 v[100:103], v[180:183], v[152:155], v[100:103]
    ds_read_b64_tr_b16 v[178:179], v17 offset:13824
    v_mfma_f32_16x16x32_bf16 v[76:79], v[180:183], v[148:151], v[76:79]
    s_add_u32 m0, s64, 0
    v_mfma_f32_16x16x32_bf16 v[52:55], v[180:183], v[144:147], v[52:55]
    s_add_u32 s71, s68, 4096
    s_waitcnt lgkmcnt(2)
    v_mfma_f32_16x16x32_bf16 v[32:35], v[160:163], v[128:131], v[32:35]
    ds_read_b64_tr_b16 v[180:181], v19 offset:12288
    v_mfma_f32_16x16x32_bf16 v[56:59], v[160:163], v[132:135], v[56:59]
    ds_read_b64_tr_b16 v[182:183], v19 offset:13824
    v_mfma_f32_16x16x32_bf16 v[80:83], v[160:163], v[136:139], v[80:83]
    buffer_load_dwordx4 v2, s[8:11], s71 offen offset:0 sc1 lds
    v_mfma_f32_16x16x32_bf16 v[104:107], v[160:163], v[140:143], v[104:107]
    buffer_load_dwordx4 v2, s[8:11], s71 offen offset:1024 sc1 lds
    v_mfma_f32_16x16x32_bf16 v[108:111], v[164:167], v[140:143], v[108:111]
    ds_read_b64_tr_b16 v[160:161], v28 offset:0
    v_mfma_f32_16x16x32_bf16 v[84:87], v[164:167], v[136:139], v[84:87]
    ds_read_b64_tr_b16 v[162:163], v28 offset:1536
    v_mfma_f32_16x16x32_bf16 v[60:63], v[164:167], v[132:135], v[60:63]
    buffer_load_dwordx4 v2, s[8:11], s71 offen offset:2048 sc1 lds
    v_mfma_f32_16x16x32_bf16 v[36:39], v[164:167], v[128:131], v[36:39]
    buffer_load_dwordx4 v2, s[8:11], s71 offen offset:3072 sc1 lds
    v_mfma_f32_16x16x32_bf16 v[40:43], v[168:171], v[128:131], v[40:43]
    ds_read_b64_tr_b16 v[164:165], v30 offset:0
    v_mfma_f32_16x16x32_bf16 v[64:67], v[168:171], v[132:135], v[64:67]
    ds_read_b64_tr_b16 v[166:167], v30 offset:1536
    v_mfma_f32_16x16x32_bf16 v[88:91], v[168:171], v[136:139], v[88:91]
    s_waitcnt vmcnt(4)
    ds_read_b64_tr_b16 v[144:145], v4 offset:4096
    v_mfma_f32_16x16x32_bf16 v[112:115], v[168:171], v[140:143], v[112:115]
    ds_read_b64_tr_b16 v[146:147], v4 offset:6144
    v_mfma_f32_16x16x32_bf16 v[116:119], v[172:175], v[140:143], v[116:119]
    ds_read_b64_tr_b16 v[168:169], v28 offset:32
    ds_read_b64_tr_b16 v[148:149], v5 offset:4096
    v_mfma_f32_16x16x32_bf16 v[92:95], v[172:175], v[136:139], v[92:95]
    ds_read_b64_tr_b16 v[170:171], v28 offset:1568
    ds_read_b64_tr_b16 v[150:151], v5 offset:6144
    v_mfma_f32_16x16x32_bf16 v[68:71], v[172:175], v[132:135], v[68:71]
    ds_read_b64_tr_b16 v[152:153], v6 offset:4096
    v_mfma_f32_16x16x32_bf16 v[44:47], v[172:175], v[128:131], v[44:47]
    ds_read_b64_tr_b16 v[154:155], v6 offset:6144
    s_waitcnt lgkmcnt(12)
    v_mfma_f32_16x16x32_bf16 v[48:51], v[176:179], v[128:131], v[48:51]
    ds_read_b64_tr_b16 v[172:173], v30 offset:32
    ds_read_b64_tr_b16 v[156:157], v7 offset:4096
    v_mfma_f32_16x16x32_bf16 v[72:75], v[176:179], v[132:135], v[72:75]
    ds_read_b64_tr_b16 v[174:175], v30 offset:1568
    ds_read_b64_tr_b16 v[158:159], v7 offset:6144
    v_mfma_f32_16x16x32_bf16 v[96:99], v[176:179], v[136:139], v[96:99]
    v_mfma_f32_16x16x32_bf16 v[120:123], v[176:179], v[140:143], v[120:123]
    s_cbranch_vccz Lsq_53
    v_mfma_f32_16x16x32_bf16 v[184:187], v[188:191], v[128:131], v[184:187]
    s_branch Lsd_54
Lsq_53:
    v_mfma_f32_16x16x32_bf16 v[184:187], v[128:131], v[128:131], v[184:187]
Lsd_54:
    v_mfma_f32_16x16x32_bf16 v[124:127], v[180:183], v[140:143], v[124:127]
    ds_read_b64_tr_b16 v[176:177], v29 offset:0
    v_mfma_f32_16x16x32_bf16 v[100:103], v[180:183], v[136:139], v[100:103]
    ds_read_b64_tr_b16 v[178:179], v29 offset:1536
    v_mfma_f32_16x16x32_bf16 v[76:79], v[180:183], v[132:135], v[76:79]
    s_add_u32 m0, s64, 4096
    v_mfma_f32_16x16x32_bf16 v[52:55], v[180:183], v[128:131], v[52:55]
    s_add_u32 s71, s68, 8192
    s_waitcnt lgkmcnt(2)
    v_mfma_f32_16x16x32_bf16 v[32:35], v[160:163], v[144:147], v[32:35]
    ds_read_b64_tr_b16 v[180:181], v31 offset:0
    v_mfma_f32_16x16x32_bf16 v[56:59], v[160:163], v[148:151], v[56:59]
    ds_read_b64_tr_b16 v[182:183], v31 offset:1536
    v_mfma_f32_16x16x32_bf16 v[80:83], v[160:163], v[152:155], v[80:83]
    buffer_load_dwordx4 v2, s[8:11], s71 offen offset:0 sc1 lds
    v_mfma_f32_16x16x32_bf16 v[104:107], v[160:163], v[156:159], v[104:107]
    buffer_load_dwordx4 v2, s[8:11], s71 offen offset:1024 sc1 lds
    v_mfma_f32_16x16x32_bf16 v[108:111], v[164:167], v[156:159], v[108:111]
    ds_read_b64_tr_b16 v[160:161], v28 offset:3072
    v_mfma_f32_16x16x32_bf16 v[84:87], v[164:167], v[152:155], v[84:87]
    ds_read_b64_tr_b16 v[162:163], v28 offset:4608
    v_mfma_f32_16x16x32_bf16 v[60:63], v[164:167], v[148:151], v[60:63]
    buffer_load_dwordx4 v2, s[8:11], s71 offen offset:2048 sc1 lds
    v_mfma_f32_16x16x32_bf16 v[36:39], v[164:167], v[144:147], v[36:39]
    buffer_load_dwordx4 v2, s[8:11], s71 offen offset:3072 sc1 lds
    v_mfma_f32_16x16x32_bf16 v[40:43], v[168:171], v[144:147], v[40:43]
    ds_read_b64_tr_b16 v[164:165], v30 offset:3072
    v_mfma_f32_16x16x32_bf16 v[64:67], v[168:171], v[148:151], v[64:67]
    ds_read_b64_tr_b16 v[166:167], v30 offset:4608
    v_mfma_f32_16x16x32_bf16 v[88:91], v[168:171], v[152:155], v[88:91]
    s_waitcnt vmcnt(4)
    ds_read_b64_tr_b16 v[128:129], v4 offset:0
    v_mfma_f32_16x16x32_bf16 v[112:115], v[168:171], v[156:159], v[112:115]
    ds_read_b64_tr_b16 v[130:131], v4 offset:2048
    v_mfma_f32_16x16x32_bf16 v[116:119], v[172:175], v[156:159], v[116:119]
    ds_read_b64_tr_b16 v[168:169], v28 offset:3104
    ds_read_b64_tr_b16 v[132:133], v5 offset:0
    v_mfma_f32_16x16x32_bf16 v[92:95], v[172:175], v[152:155], v[92:95]
    ds_read_b64_tr_b16 v[170:171], v28 offset:4640
    ds_read_b64_tr_b16 v[134:135], v5 offset:2048
    v_mfma_f32_16x16x32_bf16 v[68:71], v[172:175], v[148:151], v[68:71]
    ds_read_b64_tr_b16 v[136:137], v6 offset:0
    v_mfma_f32_16x16x32_bf16 v[44:47], v[172:175], v[144:147], v[44:47]
    ds_read_b64_tr_b16 v[138:139], v6 offset:2048
    s_waitcnt lgkmcnt(12)
    v_mfma_f32_16x16x32_bf16 v[48:51], v[176:179], v[144:147], v[48:51]
    ds_read_b64_tr_b16 v[172:173], v30 offset:3104
    ds_read_b64_tr_b16 v[140:141], v7 offset:0
    v_mfma_f32_16x16x32_bf16 v[72:75], v[176:179], v[148:151], v[72:75]
    ds_read_b64_tr_b16 v[174:175], v30 offset:4640
    ds_read_b64_tr_b16 v[142:143], v7 offset:2048
    v_mfma_f32_16x16x32_bf16 v[96:99], v[176:179], v[152:155], v[96:99]
    v_cndmask_b32 v25, v184, v185, s[86:87]
    v_mfma_f32_16x16x32_bf16 v[120:123], v[176:179], v[156:159], v[120:123]
    v_cndmask_b32 v25, v25, v186, s[88:89]
    v_mfma_f32_16x16x32_bf16 v[124:127], v[180:183], v[156:159], v[124:127]
    ds_read_b64_tr_b16 v[176:177], v29 offset:3072
    v_mfma_f32_16x16x32_bf16 v[100:103], v[180:183], v[152:155], v[100:103]
    ds_read_b64_tr_b16 v[178:179], v29 offset:4608
    v_mfma_f32_16x16x32_bf16 v[76:79], v[180:183], v[148:151], v[76:79]
    s_add_u32 m0, s64, 0
    v_cndmask_b32 v25, v25, v187, s[90:91]
    v_mfma_f32_16x16x32_bf16 v[52:55], v[180:183], v[144:147], v[52:55]
    s_add_u32 s71, s68, 12288
    s_mov_b32 exec_lo, 0x00f0000f
    s_mov_b32 exec_hi, 0xf0000f00
    s_cmp_eq_u32 s12, 1
    s_cbranch_scc1 Lf_55
    buffer_store_dword v25, v24, s[8:11], s44 offen sc1
    s_branch Lg_56
Lf_55:
    buffer_store_dword v25, v24, s[8:11], s44 offen
Lg_56:
    s_mov_b64 exec, -1
    s_waitcnt lgkmcnt(2)
    v_mfma_f32_16x16x32_bf16 v[32:35], v[160:163], v[128:131], v[32:35]
    ds_read_b64_tr_b16 v[180:181], v31 offset:3072
    v_mfma_f32_16x16x32_bf16 v[56:59], v[160:163], v[132:135], v[56:59]
    ds_read_b64_tr_b16 v[182:183], v31 offset:4608
    v_mfma_f32_16x16x32_bf16 v[80:83], v[160:163], v[136:139], v[80:83]
    buffer_load_dwordx4 v2, s[8:11], s71 offen offset:0 sc1 lds
    v_mfma_f32_16x16x32_bf16 v[104:107], v[160:163], v[140:143], v[104:107]
    buffer_load_dwordx4 v2, s[8:11], s71 offen offset:1024 sc1 lds
    v_mfma_f32_16x16x32_bf16 v[108:111], v[164:167], v[140:143], v[108:111]
    ds_read_b64_tr_b16 v[160:161], v28 offset:6144
    v_mfma_f32_16x16x32_bf16 v[84:87], v[164:167], v[136:139], v[84:87]
    ds_read_b64_tr_b16 v[162:163], v28 offset:7680
    v_mfma_f32_16x16x32_bf16 v[60:63], v[164:167], v[132:135], v[60:63]
    buffer_load_dwordx4 v2, s[8:11], s71 offen offset:2048 sc1 lds
    v_mfma_f32_16x16x32_bf16 v[36:39], v[164:167], v[128:131], v[36:39]
    buffer_load_dwordx4 v2, s[8:11], s71 offen offset:3072 sc1 lds
    v_mfma_f32_16x16x32_bf16 v[40:43], v[168:171], v[128:131], v[40:43]
    ds_read_b64_tr_b16 v[164:165], v30 offset:6144
    v_mfma_f32_16x16x32_bf16 v[64:67], v[168:171], v[132:135], v[64:67]
    ds_read_b64_tr_b16 v[166:167], v30 offset:7680
    v_mfma_f32_16x16x32_bf16 v[88:91], v[168:171], v[136:139], v[88:91]
    s_waitcnt vmcnt(5)
    ds_read_b64_tr_b16 v[144:145], v4 offset:4096
    v_mfma_f32_16x16x32_bf16 v[112:115], v[168:171], v[140:143], v[112:115]
    ds_read_b64_tr_b16 v[146:147], v4 offset:6144
    v_mfma_f32_16x16x32_bf16 v[116:119], v[172:175], v[140:143], v[116:119]
    ds_read_b64_tr_b16 v[168:169], v28 offset:6176
    ds_read_b64_tr_b16 v[148:149], v5 offset:4096
    v_mfma_f32_16x16x32_bf16 v[92:95], v[172:175], v[136:139], v[92:95]
    ds_read_b64_tr_b16 v[170:171], v28 offset:7712
    ds_read_b64_tr_b16 v[150:151], v5 offset:6144
    v_mfma_f32_16x16x32_bf16 v[68:71], v[172:175], v[132:135], v[68:71]
    ds_read_b64_tr_b16 v[152:153], v6 offset:4096
    v_mfma_f32_16x16x32_bf16 v[44:47], v[172:175], v[128:131], v[44:47]
    ds_read_b64_tr_b16 v[154:155], v6 offset:6144
    s_waitcnt lgkmcnt(12)
    v_mfma_f32_16x16x32_bf16 v[48:51], v[176:179], v[128:131], v[48:51]
    ds_read_b64_tr_b16 v[172:173], v30 offset:6176
    ds_read_b64_tr_b16 v[156:157], v7 offset:4096
    v_mfma_f32_16x16x32_bf16 v[72:75], v[176:179], v[132:135], v[72:75]
    ds_read_b64_tr_b16 v[174:175], v30 offset:7712
    ds_read_b64_tr_b16 v[158:159], v7 offset:6144
    v_mfma_f32_16x16x32_bf16 v[96:99], v[176:179], v[136:139], v[96:99]
    v_mfma_f32_16x16x32_bf16 v[120:123], v[176:179], v[140:143], v[120:123]
    v_mfma_f32_16x16x32_bf16 v[124:127], v[180:183], v[140:143], v[124:127]
    ds_read_b64_tr_b16 v[176:177], v29 offset:6144
    v_mfma_f32_16x16x32_bf16 v[100:103], v[180:183], v[136:139], v[100:103]
    ds_read_b64_tr_b16 v[178:179], v29 offset:7680
    v_mfma_f32_16x16x32_bf16 v[76:79], v[180:183], v[132:135], v[76:79]
    s_add_u32 m0, s64, 4096
    v_mfma_f32_16x16x32_bf16 v[52:55], v[180:183], v[128:131], v[52:55]
    s_add_u32 s71, s68, 16384
    s_waitcnt lgkmcnt(2)
    v_mfma_f32_16x16x32_bf16 v[32:35], v[160:163], v[144:147], v[32:35]
    ds_read_b64_tr_b16 v[180:181], v31 offset:6144
    v_mfma_f32_16x16x32_bf16 v[56:59], v[160:163], v[148:151], v[56:59]
    ds_read_b64_tr_b16 v[182:183], v31 offset:7680
    v_mfma_f32_16x16x32_bf16 v[80:83], v[160:163], v[152:155], v[80:83]
    buffer_load_dwordx4 v2, s[8:11], s71 offen offset:0 sc1 lds
    v_mfma_f32_16x16x32_bf16 v[104:107], v[160:163], v[156:159], v[104:107]
    buffer_load_dwordx4 v2, s[8:11], s71 offen offset:1024 sc1 lds
    v_mfma_f32_16x16x32_bf16 v[108:111], v[164:167], v[156:159], v[108:111]
    ds_read_b64_tr_b16 v[160:161], v28 offset:9216
    v_mfma_f32_16x16x32_bf16 v[84:87], v[164:167], v[152:155], v[84:87]
    ds_read_b64_tr_b16 v[162:163], v28 offset:10752
    v_mfma_f32_16x16x32_bf16 v[60:63], v[164:167], v[148:151], v[60:63]
    buffer_load_dwordx4 v2, s[8:11], s71 offen offset:2048 sc1 lds
    v_mfma_f32_16x16x32_bf16 v[36:39], v[164:167], v[144:147], v[36:39]
    buffer_load_dwordx4 v2, s[8:11], s71 offen offset:3072 sc1 lds
    v_mfma_f32_16x16x32_bf16 v[40:43], v[168:171], v[144:147], v[40:43]
    ds_read_b64_tr_b16 v[164:165], v30 offset:9216
    v_mfma_f32_16x16x32_bf16 v[64:67], v[168:171], v[148:151], v[64:67]
    ds_read_b64_tr_b16 v[166:167], v30 offset:10752
    v_mfma_f32_16x16x32_bf16 v[88:91], v[168:171], v[152:155], v[88:91]
    s_waitcnt vmcnt(4)
    ds_read_b64_tr_b16 v[128:129], v4 offset:0
    v_mfma_f32_16x16x32_bf16 v[112:115], v[168:171], v[156:159], v[112:115]
    ds_read_b64_tr_b16 v[130:131], v4 offset:2048
    v_mfma_f32_16x16x32_bf16 v[116:119], v[172:175], v[156:159], v[116:119]
    ds_read_b64_tr_b16 v[168:169], v28 offset:9248
    ds_read_b64_tr_b16 v[132:133], v5 offset:0
    v_mfma_f32_16x16x32_bf16 v[92:95], v[172:175], v[152:155], v[92:95]
    ds_read_b64_tr_b16 v[170:171], v28 offset:10784
    ds_read_b64_tr_b16 v[134:135], v5 offset:2048
    v_mfma_f32_16x16x32_bf16 v[68:71], v[172:175], v[148:151], v[68:71]
    ds_read_b64_tr_b16 v[136:137], v6 offset:0
    v_mfma_f32_16x16x32_bf16 v[44:47], v[172:175], v[144:147], v[44:47]
    ds_read_b64_tr_b16 v[138:139], v6 offset:2048
    s_waitcnt lgkmcnt(12)
    v_mfma_f32_16x16x32_bf16 v[48:51], v[176:179], v[144:147], v[48:51]
    ds_read_b64_tr_b16 v[172:173], v30 offset:9248
    ds_read_b64_tr_b16 v[140:141], v7 offset:0
    v_mfma_f32_16x16x32_bf16 v[72:75], v[176:179], v[148:151], v[72:75]
    ds_read_b64_tr_b16 v[174:175], v30 offset:10784
    ds_read_b64_tr_b16 v[142:143], v7 offset:2048
    v_mfma_f32_16x16x32_bf16 v[96:99], v[176:179], v[152:155], v[96:99]
    v_add_u32 v16, s84, v8
    v_mfma_f32_16x16x32_bf16 v[120:123], v[176:179], v[156:159], v[120:123]
    v_add_u32 v17, s84, v9
    v_mfma_f32_16x16x32_bf16 v[124:127], v[180:183], v[156:159], v[124:127]
    ds_read_b64_tr_b16 v[176:177], v29 offset:9216
    v_mfma_f32_16x16x32_bf16 v[100:103], v[180:183], v[152:155], v[100:103]
    ds_read_b64_tr_b16 v[178:179], v29 offset:10752
    v_mfma_f32_16x16x32_bf16 v[76:79], v[180:183], v[148:151], v[76:79]
    s_add_u32 m0, s64, 0
    v_add_u32 v18, s84, v22
    v_mfma_f32_16x16x32_bf16 v[52:55], v[180:183], v[144:147], v[52:55]
    s_add_u32 s71, s69, 0
    v_add_u32 v19, s84, v23
    s_waitcnt lgkmcnt(2)
    v_mfma_f32_16x16x32_bf16 v[32:35], v[160:163], v[128:131], v[32:35]
    ds_read_b64_tr_b16 v[180:181], v31 offset:9216
    v_mfma_f32_16x16x32_bf16 v[56:59], v[160:163], v[132:135], v[56:59]
    ds_read_b64_tr_b16 v[182:183], v31 offset:10752
    v_mfma_f32_16x16x32_bf16 v[80:83], v[160:163], v[136:139], v[80:83]
    buffer_load_dwordx4 v2, s[8:11], s71 offen offset:0 sc1 lds
    v_mfma_f32_16x16x32_bf16 v[104:107], v[160:163], v[140:143], v[104:107]
    buffer_load_dwordx4 v2, s[8:11], s71 offen offset:1024 sc1 lds
    v_mfma_f32_16x16x32_bf16 v[108:111], v[164:167], v[140:143], v[108:111]
    ds_read_b64_tr_b16 v[160:161], v28 offset:12288
    v_mfma_f32_16x16x32_bf16 v[84:87], v[164:167], v[136:139], v[84:87]
    ds_read_b64_tr_b16 v[162:163], v28 offset:13824
    v_mfma_f32_16x16x32_bf16 v[60:63], v[164:167], v[132:135], v[60:63]
    buffer_load_dwordx4 v2, s[8:11], s71 offen offset:2048 sc1 lds
    v_mfma_f32_16x16x32_bf16 v[36:39], v[164:167], v[128:131], v[36:39]
    buffer_load_dwordx4 v2, s[8:11], s71 offen offset:3072 sc1 lds
    v_mfma_f32_16x16x32_bf16 v[40:43], v[168:171], v[128:131], v[40:43]
    ds_read_b64_tr_b16 v[164:165], v30 offset:12288
    v_mfma_f32_16x16x32_bf16 v[64:67], v[168:171], v[132:135], v[64:67]
    ds_read_b64_tr_b16 v[166:167], v30 offset:13824
    v_mfma_f32_16x16x32_bf16 v[88:91], v[168:171], v[136:139], v[88:91]
    s_waitcnt vmcnt(4)
    ds_read_b64_tr_b16 v[144:145], v4 offset:4096
    v_mfma_f32_16x16x32_bf16 v[112:115], v[168:171], v[140:143], v[112:115]
    ds_read_b64_tr_b16 v[146:147], v4 offset:6144
    v_mfma_f32_16x16x32_bf16 v[116:119], v[172:175], v[140:143], v[116:119]
    ds_read_b64_tr_b16 v[168:169], v28 offset:12320
    ds_read_b64_tr_b16 v[148:149], v5 offset:4096
    v_mfma_f32_16x16x32_bf16 v[92:95], v[172:175], v[136:139], v[92:95]
    ds_read_b64_tr_b16 v[170:171], v28 offset:13856
    ds_read_b64_tr_b16 v[150:151], v5 offset:6144
    v_mfma_f32_16x16x32_bf16 v[68:71], v[172:175], v[132:135], v[68:71]
    ds_read_b64_tr_b16 v[152:153], v6 offset:4096
    v_mfma_f32_16x16x32_bf16 v[44:47], v[172:175], v[128:131], v[44:47]
    ds_read_b64_tr_b16 v[154:155], v6 offset:6144
    s_waitcnt lgkmcnt(12)
    v_mfma_f32_16x16x32_bf16 v[48:51], v[176:179], v[128:131], v[48:51]
    ds_read_b64_tr_b16 v[172:173], v30 offset:12320
    ds_read_b64_tr_b16 v[156:157], v7 offset:4096
    v_mfma_f32_16x16x32_bf16 v[72:75], v[176:179], v[132:135], v[72:75]
    ds_read_b64_tr_b16 v[174:175], v30 offset:13856
    ds_read_b64_tr_b16 v[158:159], v7 offset:6144
    v_mfma_f32_16x16x32_bf16 v[96:99], v[176:179], v[136:139], v[96:99]
    v_mfma_f32_16x16x32_bf16 v[120:123], v[176:179], v[140:143], v[120:123]
    v_mfma_f32_16x16x32_bf16 v[124:127], v[180:183], v[140:143], v[124:127]
    ds_read_b64_tr_b16 v[176:177], v29 offset:12288
    v_mfma_f32_16x16x32_bf16 v[100:103], v[180:183], v[136:139], v[100:103]
    ds_read_b64_tr_b16 v[178:179], v29 offset:13824
    v_mfma_f32_16x16x32_bf16 v[76:79], v[180:183], v[132:135], v[76:79]
    s_add_u32 m0, s64, 4096
    v_mfma_f32_16x16x32_bf16 v[52:55], v[180:183], v[128:131], v[52:55]
    s_add_u32 s71, s69, 4096
    s_waitcnt lgkmcnt(2)
    v_mfma_f32_16x16x32_bf16 v[32:35], v[160:163], v[144:147], v[32:35]
    ds_read_b64_tr_b16 v[180:181], v31 offset:12288
    v_mfma_f32_16x16x32_bf16 v[56:59], v[160:163], v[148:151], v[56:59]
    ds_read_b64_tr_b16 v[182:183], v31 offset:13824
    v_mfma_f32_16x16x32_bf16 v[80:83], v[160:163], v[152:155], v[80:83]
    buffer_load_dwordx4 v2, s[8:11], s71 offen offset:0 sc1 lds
    v_mfma_f32_16x16x32_bf16 v[104:107], v[160:163], v[156:159], v[104:107]
    buffer_load_dwordx4 v2, s[8:11], s71 offen offset:1024 sc1 lds
    v_mfma_f32_16x16x32_bf16 v[108:111], v[164:167], v[156:159], v[108:111]
    ds_read_b64_tr_b16 v[160:161], v16 offset:0
    v_mfma_f32_16x16x32_bf16 v[84:87], v[164:167], v[152:155], v[84:87]
    ds_read_b64_tr_b16 v[162:163], v16 offset:1536
    v_mfma_f32_16x16x32_bf16 v[60:63], v[164:167], v[148:151], v[60:63]
    buffer_load_dwordx4 v2, s[8:11], s71 offen offset:2048 sc1 lds
    v_mfma_f32_16x16x32_bf16 v[36:39], v[164:167], v[144:147], v[36:39]
    buffer_load_dwordx4 v2, s[8:11], s71 offen offset:3072 sc1 lds
    v_mfma_f32_16x16x32_bf16 v[40:43], v[168:171], v[144:147], v[40:43]
    ds_read_b64_tr_b16 v[164:165], v18 offset:0
    v_mfma_f32_16x16x32_bf16 v[64:67], v[168:171], v[148:151], v[64:67]
    ds_read_b64_tr_b16 v[166:167], v18 offset:1536
    v_mfma_f32_16x16x32_bf16 v[88:91], v[168:171], v[152:155], v[88:91]
    s_waitcnt vmcnt(4)
    ds_read_b64_tr_b16 v[128:129], v4 offset:0
    v_mfma_f32_16x16x32_bf16 v[112:115], v[168:171], v[156:159], v[112:115]
    ds_read_b64_tr_b16 v[130:131], v4 offset:2048
    v_mfma_f32_16x16x32_bf16 v[116:119], v[172:175], v[156:159], v[116:119]
    ds_read_b64_tr_b16 v[168:169], v16 offset:32
    ds_read_b64_tr_b16 v[132:133], v5 offset:0
    v_mfma_f32_16x16x32_bf16 v[92:95], v[172:175], v[152:155], v[92:95]
    ds_read_b64_tr_b16 v[170:171], v16 offset:1568
    ds_read_b64_tr_b16 v[134:135], v5 offset:2048
    v_mfma_f32_16x16x32_bf16 v[68:71], v[172:175], v[148:151], v[68:71]
    ds_read_b64_tr_b16 v[136:137], v6 offset:0
    v_mfma_f32_16x16x32_bf16 v[44:47], v[172:175], v[144:147], v[44:47]
    ds_read_b64_tr_b16 v[138:139], v6 offset:2048
    s_waitcnt lgkmcnt(12)
    v_mfma_f32_16x16x32_bf16 v[48:51], v[176:179], v[144:147], v[48:51]
    ds_read_b64_tr_b16 v[172:173], v18 offset:32
    ds_read_b64_tr_b16 v[140:141], v7 offset:0
    v_mfma_f32_16x16x32_bf16 v[72:75], v[176:179], v[148:151], v[72:75]
    ds_read_b64_tr_b16 v[174:175], v18 offset:1568
    ds_read_b64_tr_b16 v[142:143], v7 offset:2048
    v_mfma_f32_16x16x32_bf16 v[96:99], v[176:179], v[152:155], v[96:99]
    v_mfma_f32_16x16x32_bf16 v[120:123], v[176:179], v[156:159], v[120:123]
    v_mfma_f32_16x16x32_bf16 v[124:127], v[180:183], v[156:159], v[124:127]
    ds_read_b64_tr_b16 v[176:177], v17 offset:0
    v_mfma_f32_16x16x32_bf16 v[100:103], v[180:183], v[152:155], v[100:103]
    ds_read_b64_tr_b16 v[178:179], v17 offset:1536
    v_mfma_f32_16x16x32_bf16 v[76:79], v[180:183], v[148:151], v[76:79]
    s_add_u32 m0, s64, 0
    v_mfma_f32_16x16x32_bf16 v[52:55], v[180:183], v[144:147], v[52:55]
    s_add_u32 s71, s69, 8192
    s_waitcnt lgkmcnt(2)
    v_mfma_f32_16x16x32_bf16 v[32:35], v[160:163], v[128:131], v[32:35]
    ds_read_b64_tr_b16 v[180:181], v19 offset:0
    v_mfma_f32_16x16x32_bf16 v[56:59], v[160:163], v[132:135], v[56:59]
    ds_read_b64_tr_b16 v[182:183], v19 offset:1536
    v_mfma_f32_16x16x32_bf16 v[80:83], v[160:163], v[136:139], v[80:83]
    buffer_load_dwordx4 v2, s[8:11], s71 offen offset:0 sc1 lds
    v_mfma_f32_16x16x32_bf16 v[104:107], v[160:163], v[140:143], v[104:107]
    buffer_load_dwordx4 v2, s[8:11], s71 offen offset:1024 sc1 lds
    v_mfma_f32_16x16x32_bf16 v[108:111], v[164:167], v[140:143], v[108:111]
    ds_read_b64_tr_b16 v[160:161], v16 offset:3072
    buffer_load_dwordx4 v[224:227], v26, s[8:11], s49 offen offset:0
    v_mfma_f32_16x16x32_bf16 v[84:87], v[164:167], v[136:139], v[84:87]
    ds_read_b64_tr_b16 v[162:163], v16 offset:4608
    buffer_load_dwordx4 v[228:231], v26, s[8:11], s49 offen offset:64
    v_mfma_f32_16x16x32_bf16 v[60:63], v[164:167], v[132:135], v[60:63]
    buffer_load_dwordx4 v2, s[8:11], s71 offen offset:2048 sc1 lds
    v_mfma_f32_16x16x32_bf16 v[36:39], v[164:167], v[128:131], v[36:39]
    buffer_load_dwordx4 v2, s[8:11], s71 offen offset:3072 sc1 lds
    v_mfma_f32_16x16x32_bf16 v[40:43], v[168:171], v[128:131], v[40:43]
    ds_read_b64_tr_b16 v[164:165], v18 offset:3072
    v_mfma_f32_16x16x32_bf16 v[64:67], v[168:171], v[132:135], v[64:67]
    ds_read_b64_tr_b16 v[166:167], v18 offset:4608
    v_mfma_f32_16x16x32_bf16 v[88:91], v[168:171], v[136:139], v[88:91]
    s_waitcnt vmcnt(6)
    ds_read_b64_tr_b16 v[144:145], v4 offset:4096
    v_mfma_f32_16x16x32_bf16 v[112:115], v[168:171], v[140:143], v[112:115]
    ds_read_b64_tr_b16 v[146:147], v4 offset:6144
    v_mfma_f32_16x16x32_bf16 v[116:119], v[172:175], v[140:143], v[116:119]
    ds_read_b64_tr_b16 v[168:169], v16 offset:3104
    ds_read_b64_tr_b16 v[148:149], v5 offset:4096
    v_mfma_f32_16x16x32_bf16 v[92:95], v[172:175], v[136:139], v[92:95]
    ds_read_b64_tr_b16 v[170:171], v16 offset:4640
    ds_read_b64_tr_b16 v[150:151], v5 offset:6144
    v_mfma_f32_16x16x32_bf16 v[68:71], v[172:175], v[132:135], v[68:71]
    ds_read_b64_tr_b16 v[152:153], v6 offset:4096
    v_mfma_f32_16x16x32_bf16 v[44:47], v[172:175], v[128:131], v[44:47]
    ds_read_b64_tr_b16 v[154:155], v6 offset:6144
    s_waitcnt lgkmcnt(12)
    v_mfma_f32_16x16x32_bf16 v[48:51], v[176:179], v[128:131], v[48:51]
    ds_read_b64_tr_b16 v[172:173], v18 offset:3104
    ds_read_b64_tr_b16 v[156:157], v7 offset:4096
    v_mfma_f32_16x16x32_bf16 v[72:75], v[176:179], v[132:135], v[72:75]
    ds_read_b64_tr_b16 v[174:175], v18 offset:4640
    ds_read_b64_tr_b16 v[158:159], v7 offset:6144
    v_mfma_f32_16x16x32_bf16 v[96:99], v[176:179], v[136:139], v[96:99]
    buffer_load_dwordx4 v[232:235], v26, s[8:11], s49 offen offset:128
    v_mfma_f32_16x16x32_bf16 v[120:123], v[176:179], v[140:143], v[120:123]
    buffer_load_dwordx4 v[236:239], v26, s[8:11], s49 offen offset:192
    v_mfma_f32_16x16x32_bf16 v[124:127], v[180:183], v[140:143], v[124:127]
    ds_read_b64_tr_b16 v[176:177], v17 offset:3072
    v_mfma_f32_16x16x32_bf16 v[100:103], v[180:183], v[136:139], v[100:103]
    ds_read_b64_tr_b16 v[178:179], v17 offset:4608
    v_mfma_f32_16x16x32_bf16 v[76:79], v[180:183], v[132:135], v[76:79]
    s_add_u32 m0, s64, 4096
    buffer_load_dwordx4 v[240:243], v26, s[8:11], s50 offen offset:0
    v_mfma_f32_16x16x32_bf16 v[52:55], v[180:183], v[128:131], v[52:55]
    s_add_u32 s71, s69, 12288
    buffer_load_dwordx4 v[244:247], v26, s[8:11], s50 offen offset:64
    s_waitcnt lgkmcnt(2)
    v_mfma_f32_16x16x32_bf16 v[32:35], v[160:163], v[144:147], v[32:35]
    ds_read_b64_tr_b16 v[180:181], v19 offset:3072
    v_mfma_f32_16x16x32_bf16 v[56:59], v[160:163], v[148:151], v[56:59]
    ds_read_b64_tr_b16 v[182:183], v19 offset:4608
    v_mfma_f32_16x16x32_bf16 v[80:83], v[160:163], v[152:155], v[80:83]
    buffer_load_dwordx4 v2, s[8:11], s71 offen offset:0 sc1 lds
    v_mfma_f32_16x16x32_bf16 v[104:107], v[160:163], v[156:159], v[104:107]
    buffer_load_dwordx4 v2, s[8:11], s71 offen offset:1024 sc1 lds
    v_mfma_f32_16x16x32_bf16 v[108:111], v[164:167], v[156:159], v[108:111]
    ds_read_b64_tr_b16 v[160:161], v16 offset:6144
    v_mfma_f32_16x16x32_bf16 v[84:87], v[164:167], v[152:155], v[84:87]
    ds_read_b64_tr_b16 v[162:163], v16 offset:7680
    v_mfma_f32_16x16x32_bf16 v[60:63], v[164:167], v[148:151], v[60:63]
    buffer_load_dwordx4 v2, s[8:11], s71 offen offset:2048 sc1 lds
    v_mfma_f32_16x16x32_bf16 v[36:39], v[164:167], v[144:147], v[36:39]
    buffer_load_dwordx4 v2, s[8:11], s71 offen offset:3072 sc1 lds
    v_mfma_f32_16x16x32_bf16 v[40:43], v[168:171], v[144:147], v[40:43]
    ds_read_b64_tr_b16 v[164:165], v18 offset:6144
    v_mfma_f32_16x16x32_bf16 v[64:67], v[168:171], v[148:151], v[64:67]
    ds_read_b64_tr_b16 v[166:167], v18 offset:7680
    v_mfma_f32_16x16x32_bf16 v[88:91], v[168:171], v[152:155], v[88:91]
    s_waitcnt vmcnt(8)
    ds_read_b64_tr_b16 v[128:129], v4 offset:0
    v_mfma_f32_16x16x32_bf16 v[112:115], v[168:171], v[156:159], v[112:115]
    ds_read_b64_tr_b16 v[130:131], v4 offset:2048
    v_mfma_f32_16x16x32_bf16 v[116:119], v[172:175], v[156:159], v[116:119]
    ds_read_b64_tr_b16 v[168:169], v16 offset:6176
    ds_read_b64_tr_b16 v[132:133], v5 offset:0
    v_mfma_f32_16x16x32_bf16 v[92:95], v[172:175], v[152:155], v[92:95]
    ds_read_b64_tr_b16 v[170:171], v16 offset:7712
    ds_read_b64_tr_b16 v[134:135], v5 offset:2048
    v_mfma_f32_16x16x32_bf16 v[68:71], v[172:175], v[148:151], v[68:71]
    ds_read_b64_tr_b16 v[136:137], v6 offset:0
    v_mfma_f32_16x16x32_bf16 v[44:47], v[172:175], v[144:147], v[44:47]
    ds_read_b64_tr_b16 v[138:139], v6 offset:2048
    s_waitcnt lgkmcnt(12)
    v_mfma_f32_16x16x32_bf16 v[48:51], v[176:179], v[144:147], v[48:51]
    ds_read_b64_tr_b16 v[172:173], v18 offset:6176
    ds_read_b64_tr_b16 v[140:141], v7 offset:0
    v_mfma_f32_16x16x32_bf16 v[72:75], v[176:179], v[148:151], v[72:75]
    ds_read_b64_tr_b16 v[174:175], v18 offset:7712
    ds_read_b64_tr_b16 v[142:143], v7 offset:2048
    v_mfma_f32_16x16x32_bf16 v[96:99], v[176:179], v[152:155], v[96:99]
    v_mfma_f32_16x16x32_bf16 v[120:123], v[176:179], v[156:159], v[120:123]
    v_mfma_f32_16x16x32_bf16 v[124:127], v[180:183], v[156:159], v[124:127]
    ds_read_b64_tr_b16 v[176:177], v17 offset:6144
    v_mfma_f32_16x16x32_bf16 v[100:103], v[180:183], v[152:155], v[100:103]
    ds_read_b64_tr_b16 v[178:179], v17 offset:7680
    v_mfma_f32_16x16x32_bf16 v[76:79], v[180:183], v[148:151], v[76:79]
    s_add_u32 m0, s64, 0
    v_mfma_f32_16x16x32_bf16 v[52:55], v[180:183], v[144:147], v[52:55]
    s_add_u32 s71, s69, 16384
    s_waitcnt lgkmcnt(2)
    v_mfma_f32_16x16x32_bf16 v[32:35], v[160:163], v[128:131], v[32:35]
    ds_read_b64_tr_b16 v[180:181], v19 offset:6144
    v_mfma_f32_16x16x32_bf16 v[56:59], v[160:163], v[132:135], v[56:59]
    ds_read_b64_tr_b16 v[182:183], v19 offset:7680
    v_mfma_f32_16x16x32_bf16 v[80:83], v[160:163], v[136:139], v[80:83]
    buffer_load_dwordx4 v2, s[8:11], s71 offen offset:0 sc1 lds
    v_mfma_f32_16x16x32_bf16 v[104:107], v[160:163], v[140:143], v[104:107]
    buffer_load_dwordx4 v2, s[8:11], s71 offen offset:1024 sc1 lds
    v_mfma_f32_16x16x32_bf16 v[108:111], v[164:167], v[140:143], v[108:111]
    ds_read_b64_tr_b16 v[160:161], v16 offset:9216
    v_mfma_f32_16x16x32_bf16 v[84:87], v[164:167], v[136:139], v[84:87]
    ds_read_b64_tr_b16 v[162:163], v16 offset:10752
    v_mfma_f32_16x16x32_bf16 v[60:63], v[164:167], v[132:135], v[60:63]
    buffer_load_dwordx4 v2, s[8:11], s71 offen offset:2048 sc1 lds
    v_mfma_f32_16x16x32_bf16 v[36:39], v[164:167], v[128:131], v[36:39]
    buffer_load_dwordx4 v2, s[8:11], s71 offen offset:3072 sc1 lds
    v_mfma_f32_16x16x32_bf16 v[40:43], v[168:171], v[128:131], v[40:43]
    ds_read_b64_tr_b16 v[164:165], v18 offset:9216
    v_mfma_f32_16x16x32_bf16 v[64:67], v[168:171], v[132:135], v[64:67]
    ds_read_b64_tr_b16 v[166:167], v18 offset:10752
    v_mfma_f32_16x16x32_bf16 v[88:91], v[168:171], v[136:139], v[88:91]
    s_waitcnt vmcnt(4)
    ds_read_b64_tr_b16 v[144:145], v4 offset:4096
    v_mfma_f32_16x16x32_bf16 v[112:115], v[168:171], v[140:143], v[112:115]
    ds_read_b64_tr_b16 v[146:147], v4 offset:6144
    v_mfma_f32_16x16x32_bf16 v[116:119], v[172:175], v[140:143], v[116:119]
    ds_read_b64_tr_b16 v[168:169], v16 offset:9248
    ds_read_b64_tr_b16 v[148:149], v5 offset:4096
    v_mfma_f32_16x16x32_bf16 v[92:95], v[172:175], v[136:139], v[92:95]
    ds_read_b64_tr_b16 v[170:171], v16 offset:10784
    ds_read_b64_tr_b16 v[150:151], v5 offset:6144
    v_mfma_f32_16x16x32_bf16 v[68:71], v[172:175], v[132:135], v[68:71]
    ds_read_b64_tr_b16 v[152:153], v6 offset:4096
    v_mfma_f32_16x16x32_bf16 v[44:47], v[172:175], v[128:131], v[44:47]
    ds_read_b64_tr_b16 v[154:155], v6 offset:6144
    s_waitcnt lgkmcnt(12)
    v_mfma_f32_16x16x32_bf16 v[48:51], v[176:179], v[128:131], v[48:51]
    ds_read_b64_tr_b16 v[172:173], v18 offset:9248
    ds_read_b64_tr_b16 v[156:157], v7 offset:4096
    v_mfma_f32_16x16x32_bf16 v[72:75], v[176:179], v[132:135], v[72:75]
    ds_read_b64_tr_b16 v[174:175], v18 offset:10784
    ds_read_b64_tr_b16 v[158:159], v7 offset:6144
    v_mfma_f32_16x16x32_bf16 v[96:99], v[176:179], v[136:139], v[96:99]
    v_add_u32 v28, s85, v8
    v_mfma_f32_16x16x32_bf16 v[120:123], v[176:179], v[140:143], v[120:123]
    v_add_u32 v29, s85, v9
    v_mfma_f32_16x16x32_bf16 v[124:127], v[180:183], v[140:143], v[124:127]
    ds_read_b64_tr_b16 v[176:177], v17 offset:9216
    v_mfma_f32_16x16x32_bf16 v[100:103], v[180:183], v[136:139], v[100:103]
    ds_read_b64_tr_b16 v[178:179], v17 offset:10752
    v_mfma_f32_16x16x32_bf16 v[76:79], v[180:183], v[132:135], v[76:79]
    s_add_u32 m0, s64, 4096
    v_add_u32 v30, s85, v22
    v_mfma_f32_16x16x32_bf16 v[52:55], v[180:183], v[128:131], v[52:55]
    s_add_u32 s71, s70, 0
    v_add_u32 v31, s85, v23
    s_waitcnt lgkmcnt(2)
    v_mfma_f32_16x16x32_bf16 v[32:35], v[160:163], v[144:147], v[32:35]
    ds_read_b64_tr_b16 v[180:181], v19 offset:9216
    v_mfma_f32_16x16x32_bf16 v[56:59], v[160:163], v[148:151], v[56:59]
    ds_read_b64_tr_b16 v[182:183], v19 offset:10752
    v_mfma_f32_16x16x32_bf16 v[80:83], v[160:163], v[152:155], v[80:83]
    buffer_load_dwordx4 v2, s[8:11], s71 offen offset:0 sc1 lds
    v_mfma_f32_16x16x32_bf16 v[104:107], v[160:163], v[156:159], v[104:107]
    buffer_load_dwordx4 v2, s[8:11], s71 offen offset:1024 sc1 lds
    v_mfma_f32_16x16x32_bf16 v[108:111], v[164:167], v[156:159], v[108:111]
    ds_read_b64_tr_b16 v[160:161], v16 offset:12288
    v_mfma_f32_16x16x32_bf16 v[84:87], v[164:167], v[152:155], v[84:87]
    ds_read_b64_tr_b16 v[162:163], v16 offset:13824
    v_mfma_f32_16x16x32_bf16 v[60:63], v[164:167], v[148:151], v[60:63]
    buffer_load_dwordx4 v2, s[8:11], s71 offen offset:2048 sc1 lds
    v_mfma_f32_16x16x32_bf16 v[36:39], v[164:167], v[144:147], v[36:39]
    buffer_load_dwordx4 v2, s[8:11], s71 offen offset:3072 sc1 lds
    v_mfma_f32_16x16x32_bf16 v[40:43], v[168:171], v[144:147], v[40:43]
    ds_read_b64_tr_b16 v[164:165], v18 offset:12288
    v_mfma_f32_16x16x32_bf16 v[64:67], v[168:171], v[148:151], v[64:67]
    ds_read_b64_tr_b16 v[166:167], v18 offset:13824
    v_mfma_f32_16x16x32_bf16 v[88:91], v[168:171], v[152:155], v[88:91]
    s_waitcnt vmcnt(4)
    ds_read_b64_tr_b16 v[128:129], v4 offset:0
    v_mfma_f32_16x16x32_bf16 v[112:115], v[168:171], v[156:159], v[112:115]
    ds_read_b64_tr_b16 v[130:131], v4 offset:2048
    v_mfma_f32_16x16x32_bf16 v[116:119], v[172:175], v[156:159], v[116:119]
    ds_read_b64_tr_b16 v[168:169], v16 offset:12320
    ds_read_b64_tr_b16 v[132:133], v5 offset:0
    v_mfma_f32_16x16x32_bf16 v[92:95], v[172:175], v[152:155], v[92:95]
    ds_read_b64_tr_b16 v[170:171], v16 offset:13856
    ds_read_b64_tr_b16 v[134:135], v5 offset:2048
    v_mfma_f32_16x16x32_bf16 v[68:71], v[172:175], v[148:151], v[68:71]
    ds_read_b64_tr_b16 v[136:137], v6 offset:0
    v_mfma_f32_16x16x32_bf16 v[44:47], v[172:175], v[144:147], v[44:47]
    ds_read_b64_tr_b16 v[138:139], v6 offset:2048
    s_waitcnt lgkmcnt(12)
    v_mfma_f32_16x16x32_bf16 v[48:51], v[176:179], v[144:147], v[48:51]
    ds_read_b64_tr_b16 v[172:173], v18 offset:12320
    ds_read_b64_tr_b16 v[140:141], v7 offset:0
    v_mfma_f32_16x16x32_bf16 v[72:75], v[176:179], v[148:151], v[72:75]
    ds_read_b64_tr_b16 v[174:175], v18 offset:13856
    ds_read_b64_tr_b16 v[142:143], v7 offset:2048
    v_mfma_f32_16x16x32_bf16 v[96:99], v[176:179], v[152:155], v[96:99]
    buffer_load_dwordx4 v[192:195], v24, s[8:11], s45 offen sc1
    v_mfma_f32_16x16x32_bf16 v[120:123], v[176:179], v[156:159], v[120:123]
    buffer_load_dwordx4 v[196:199], v24, s[8:11], s45 offen offset:16 sc1
    v_mfma_f32_16x16x32_bf16 v[124:127], v[180:183], v[156:159], v[124:127]
    ds_read_b64_tr_b16 v[176:177], v17 offset:12288
    v_mfma_f32_16x16x32_bf16 v[100:103], v[180:183], v[152:155], v[100:103]
    ds_read_b64_tr_b16 v[178:179], v17 offset:13824
    v_mfma_f32_16x16x32_bf16 v[76:79], v[180:183], v[148:151], v[76:79]
    s_add_u32 m0, s64, 0
    buffer_load_dwordx4 v[200:203], v24, s[8:11], s46 offen sc1
    v_mfma_f32_16x16x32_bf16 v[52:55], v[180:183], v[144:147], v[52:55]
    s_add_u32 s71, s70, 4096
    buffer_load_dwordx4 v[204:207], v24, s[8:11], s46 offen offset:16 sc1
    s_waitcnt lgkmcnt(2)
    v_mfma_f32_16x16x32_bf16 v[32:35], v[160:163], v[128:131], v[32:35]
    ds_read_b64_tr_b16 v[180:181], v19 offset:12288
    v_mfma_f32_16x16x32_bf16 v[56:59], v[160:163], v[132:135], v[56:59]
    ds_read_b64_tr_b16 v[182:183], v19 offset:13824
    v_mfma_f32_16x16x32_bf16 v[80:83], v[160:163], v[136:139], v[80:83]
    buffer_load_dwordx4 v2, s[8:11], s71 offen offset:0 sc1 lds
    v_mfma_f32_16x16x32_bf16 v[104:107], v[160:163], v[140:143], v[104:107]
    buffer_load_dwordx4 v2, s[8:11], s71 offen offset:1024 sc1 lds
    v_mfma_f32_16x16x32_bf16 v[108:111], v[164:167], v[140:143], v[108:111]
    ds_read_b64_tr_b16 v[160:161], v28 offset:0
    v_mfma_f32_16x16x32_bf16 v[84:87], v[164:167], v[136:139], v[84:87]
    ds_read_b64_tr_b16 v[162:163], v28 offset:1536
    v_mfma_f32_16x16x32_bf16 v[60:63], v[164:167], v[132:135], v[60:63]
    buffer_load_dwordx4 v2, s[8:11], s71 offen offset:2048 sc1 lds
    v_mfma_f32_16x16x32_bf16 v[36:39], v[164:167], v[128:131], v[36:39]
    buffer_load_dwordx4 v2, s[8:11], s71 offen offset:3072 sc1 lds
    v_mfma_f32_16x16x32_bf16 v[40:43], v[168:171], v[128:131], v[40:43]
    ds_read_b64_tr_b16 v[164:165], v30 offset:0
    v_mfma_f32_16x16x32_bf16 v[64:67], v[168:171], v[132:135], v[64:67]
    ds_read_b64_tr_b16 v[166:167], v30 offset:1536
    v_mfma_f32_16x16x32_bf16 v[88:91], v[168:171], v[136:139], v[88:91]
    s_waitcnt vmcnt(8)
    ds_read_b64_tr_b16 v[144:145], v4 offset:4096
    v_mfma_f32_16x16x32_bf16 v[112:115], v[168:171], v[140:143], v[112:115]
    ds_read_b64_tr_b16 v[146:147], v4 offset:6144
    v_mfma_f32_16x16x32_bf16 v[116:119], v[172:175], v[140:143], v[116:119]
    ds_read_b64_tr_b16 v[168:169], v28 offset:32
    ds_read_b64_tr_b16 v[148:149], v5 offset:4096
    v_mfma_f32_16x16x32_bf16 v[92:95], v[172:175], v[136:139], v[92:95]
    ds_read_b64_tr_b16 v[170:171], v28 offset:1568
    ds_read_b64_tr_b16 v[150:151], v5 offset:6144
    v_mfma_f32_16x16x32_bf16 v[68:71], v[172:175], v[132:135], v[68:71]
    ds_read_b64_tr_b16 v[152:153], v6 offset:4096
    v_mfma_f32_16x16x32_bf16 v[44:47], v[172:175], v[128:131], v[44:47]
    ds_read_b64_tr_b16 v[154:155], v6 offset:6144
    s_waitcnt lgkmcnt(12)
    v_mfma_f32_16x16x32_bf16 v[48:51], v[176:179], v[128:131], v[48:51]
    ds_read_b64_tr_b16 v[172:173], v30 offset:32
    ds_read_b64_tr_b16 v[156:157], v7 offset:4096
    v_mfma_f32_16x16x32_bf16 v[72:75], v[176:179], v[132:135], v[72:75]
    ds_read_b64_tr_b16 v[174:175], v30 offset:1568
    ds_read_b64_tr_b16 v[158:159], v7 offset:6144
    v_mfma_f32_16x16x32_bf16 v[96:99], v[176:179], v[136:139], v[96:99]
    buffer_load_dwordx4 v[208:211], v24, s[8:11], s47 offen sc1
    v_mfma_f32_16x16x32_bf16 v[120:123], v[176:179], v[140:143], v[120:123]
    buffer_load_dwordx4 v[212:215], v24, s[8:11], s47 offen offset:16 sc1
    v_mfma_f32_16x16x32_bf16 v[124:127], v[180:183], v[140:143], v[124:127]
    ds_read_b64_tr_b16 v[176:177], v29 offset:0
    v_mfma_f32_16x16x32_bf16 v[100:103], v[180:183], v[136:139], v[100:103]
    ds_read_b64_tr_b16 v[178:179], v29 offset:1536
    v_mfma_f32_16x16x32_bf16 v[76:79], v[180:183], v[132:135], v[76:79]
    s_add_u32 m0, s64, 4096
    buffer_load_dwordx4 v[216:219], v24, s[8:11], s48 offen sc1
    v_mfma_f32_16x16x32_bf16 v[52:55], v[180:183], v[128:131], v[52:55]
    s_add_u32 s71, s70, 8192
    buffer_load_dwordx4 v[220:223], v24, s[8:11], s48 offen offset:16 sc1
    s_waitcnt lgkmcnt(2)
    v_mfma_f32_16x16x32_bf16 v[32:35], v[160:163], v[144:147], v[32:35]
    ds_read_b64_tr_b16 v[180:181], v31 offset:0
    v_mfma_f32_16x16x32_bf16 v[56:59], v[160:163], v[148:151], v[56:59]
    ds_read_b64_tr_b16 v[182:183], v31 offset:1536
    v_mfma_f32_16x16x32_bf16 v[80:83], v[160:163], v[152:155], v[80:83]
    buffer_load_dwordx4 v2, s[8:11], s71 offen offset:0 sc1 lds
    v_mfma_f32_16x16x32_bf16 v[104:107], v[160:163], v[156:159], v[104:107]
    buffer_load_dwordx4 v2, s[8:11], s71 offen offset:1024 sc1 lds
    v_mfma_f32_16x16x32_bf16 v[108:111], v[164:167], v[156:159], v[108:111]
    ds_read_b64_tr_b16 v[160:161], v28 offset:3072
    v_mfma_f32_16x16x32_bf16 v[84:87], v[164:167], v[152:155], v[84:87]
    ds_read_b64_tr_b16 v[162:163], v28 offset:4608
    v_mfma_f32_16x16x32_bf16 v[60:63], v[164:167], v[148:151], v[60:63]
    buffer_load_dwordx4 v2, s[8:11], s71 offen offset:2048 sc1 lds
    v_mfma_f32_16x16x32_bf16 v[36:39], v[164:167], v[144:147], v[36:39]
    buffer_load_dwordx4 v2, s[8:11], s71 offen offset:3072 sc1 lds
    v_mfma_f32_16x16x32_bf16 v[40:43], v[168:171], v[144:147], v[40:43]
    ds_read_b64_tr_b16 v[164:165], v30 offset:3072
    v_mfma_f32_16x16x32_bf16 v[64:67], v[168:171], v[148:151], v[64:67]
    ds_read_b64_tr_b16 v[166:167], v30 offset:4608
    v_mfma_f32_16x16x32_bf16 v[88:91], v[168:171], v[152:155], v[88:91]
    s_waitcnt vmcnt(8)
    ds_read_b64_tr_b16 v[128:129], v4 offset:0
    v_mfma_f32_16x16x32_bf16 v[112:115], v[168:171], v[156:159], v[112:115]
    ds_read_b64_tr_b16 v[130:131], v4 offset:2048
    v_mfma_f32_16x16x32_bf16 v[116:119], v[172:175], v[156:159], v[116:119]
    ds_read_b64_tr_b16 v[168:169], v28 offset:3104
    ds_read_b64_tr_b16 v[132:133], v5 offset:0
    v_mfma_f32_16x16x32_bf16 v[92:95], v[172:175], v[152:155], v[92:95]
    ds_read_b64_tr_b16 v[170:171], v28 offset:4640
    ds_read_b64_tr_b16 v[134:135], v5 offset:2048
    v_mfma_f32_16x16x32_bf16 v[68:71], v[172:175], v[148:151], v[68:71]
    ds_read_b64_tr_b16 v[136:137], v6 offset:0
    v_mfma_f32_16x16x32_bf16 v[44:47], v[172:175], v[144:147], v[44:47]
    ds_read_b64_tr_b16 v[138:139], v6 offset:2048
    s_waitcnt lgkmcnt(12)
    v_mfma_f32_16x16x32_bf16 v[48:51], v[176:179], v[144:147], v[48:51]
    ds_read_b64_tr_b16 v[172:173], v30 offset:3104
    ds_read_b64_tr_b16 v[140:141], v7 offset:0
    v_mfma_f32_16x16x32_bf16 v[72:75], v[176:179], v[148:151], v[72:75]
    ds_read_b64_tr_b16 v[174:175], v30 offset:4640
    ds_read_b64_tr_b16 v[142:143], v7 offset:2048
    v_mfma_f32_16x16x32_bf16 v[96:99], v[176:179], v[152:155], v[96:99]
    v_mfma_f32_16x16x32_bf16 v[120:123], v[176:179], v[156:159], v[120:123]
    v_mfma_f32_16x16x32_bf16 v[124:127], v[180:183], v[156:159], v[124:127]
    ds_read_b64_tr_b16 v[176:177], v29 offset:3072
    v_mfma_f32_16x16x32_bf16 v[100:103], v[180:183], v[152:155], v[100:103]
    ds_read_b64_tr_b16 v[178:179], v29 offset:4608
    v_mfma_f32_16x16x32_bf16 v[76:79], v[180:183], v[148:151], v[76:79]
    s_add_u32 m0, s64, 0
    v_mfma_f32_16x16x32_bf16 v[52:55], v[180:183], v[144:147], v[52:55]
    s_add_u32 s71, s70, 12288
    s_waitcnt lgkmcnt(2)
    v_mfma_f32_16x16x32_bf16 v[32:35], v[160:163], v[128:131], v[32:35]
    ds_read_b64_tr_b16 v[180:181], v31 offset:3072
    v_mfma_f32_16x16x32_bf16 v[56:59], v[160:163], v[132:135], v[56:59]
    ds_read_b64_tr_b16 v[182:183], v31 offset:4608
    v_mfma_f32_16x16x32_bf16 v[80:83], v[160:163], v[136:139], v[80:83]
    buffer_load_dwordx4 v2, s[8:11], s71 offen offset:0 sc1 lds
    v_mfma_f32_16x16x32_bf16 v[104:107], v[160:163], v[140:143], v[104:107]
    buffer_load_dwordx4 v2, s[8:11], s71 offen offset:1024 sc1 lds
    v_mfma_f32_16x16x32_bf16 v[108:111], v[164:167], v[140:143], v[108:111]
    ds_read_b64_tr_b16 v[160:161], v28 offset:6144
    v_mfma_f32_16x16x32_bf16 v[84:87], v[164:167], v[136:139], v[84:87]
    ds_read_b64_tr_b16 v[162:163], v28 offset:7680
    v_mfma_f32_16x16x32_bf16 v[60:63], v[164:167], v[132:135], v[60:63]
    buffer_load_dwordx4 v2, s[8:11], s71 offen offset:2048 sc1 lds
    v_mfma_f32_16x16x32_bf16 v[36:39], v[164:167], v[128:131], v[36:39]
    buffer_load_dwordx4 v2, s[8:11], s71 offen offset:3072 sc1 lds
    v_mfma_f32_16x16x32_bf16 v[40:43], v[168:171], v[128:131], v[40:43]
    ds_read_b64_tr_b16 v[164:165], v30 offset:6144
    v_mfma_f32_16x16x32_bf16 v[64:67], v[168:171], v[132:135], v[64:67]
    ds_read_b64_tr_b16 v[166:167], v30 offset:7680
    v_mfma_f32_16x16x32_bf16 v[88:91], v[168:171], v[136:139], v[88:91]
    s_waitcnt vmcnt(4)
    ds_read_b64_tr_b16 v[144:145], v4 offset:4096
    v_mfma_f32_16x16x32_bf16 v[112:115], v[168:171], v[140:143], v[112:115]
    ds_read_b64_tr_b16 v[146:147], v4 offset:6144
    v_mfma_f32_16x16x32_bf16 v[116:119], v[172:175], v[140:143], v[116:119]
    ds_read_b64_tr_b16 v[168:169], v28 offset:6176
    ds_read_b64_tr_b16 v[148:149], v5 offset:4096
    v_mfma_f32_16x16x32_bf16 v[92:95], v[172:175], v[136:139], v[92:95]
    ds_read_b64_tr_b16 v[170:171], v28 offset:7712
    ds_read_b64_tr_b16 v[150:151], v5 offset:6144
    v_mfma_f32_16x16x32_bf16 v[68:71], v[172:175], v[132:135], v[68:71]
    ds_read_b64_tr_b16 v[152:153], v6 offset:4096
    v_mfma_f32_16x16x32_bf16 v[44:47], v[172:175], v[128:131], v[44:47]
    ds_read_b64_tr_b16 v[154:155], v6 offset:6144
    s_waitcnt lgkmcnt(12)
    v_mfma_f32_16x16x32_bf16 v[48:51], v[176:179], v[128:131], v[48:51]
    ds_read_b64_tr_b16 v[172:173], v30 offset:6176
    ds_read_b64_tr_b16 v[156:157], v7 offset:4096
    v_mfma_f32_16x16x32_bf16 v[72:75], v[176:179], v[132:135], v[72:75]
    ds_read_b64_tr_b16 v[174:175], v30 offset:7712
    ds_read_b64_tr_b16 v[158:159], v7 offset:6144
    v_mfma_f32_16x16x32_bf16 v[96:99], v[176:179], v[136:139], v[96:99]
    v_max3_u32 v25, v192, v193, v194
    v_mfma_f32_16x16x32_bf16 v[120:123], v[176:179], v[140:143], v[120:123]
    v_max3_u32 v25, v25, v195, v196
    v_mfma_f32_16x16x32_bf16 v[124:127], v[180:183], v[140:143], v[124:127]
    ds_read_b64_tr_b16 v[176:177], v29 offset:6144
    v_max3_u32 v25, v25, v197, v198
    v_mfma_f32_16x16x32_bf16 v[100:103], v[180:183], v[136:139], v[100:103]
    ds_read_b64_tr_b16 v[178:179], v29 offset:7680
    v_max3_u32 v25, v25, v199, v200
    v_mfma_f32_16x16x32_bf16 v[76:79], v[180:183], v[132:135], v[76:79]
    s_add_u32 m0, s64, 4096
    v_max3_u32 v25, v25, v201, v202
    v_mfma_f32_16x16x32_bf16 v[52:55], v[180:183], v[128:131], v[52:55]
    s_add_u32 s71, s70, 16384
    v_max3_u32 v25, v25, v203, v204
    s_waitcnt lgkmcnt(2)
    v_mfma_f32_16x16x32_bf16 v[32:35], v[160:163], v[144:147], v[32:35]
    ds_read_b64_tr_b16 v[180:181], v31 offset:6144
    v_max3_u32 v25, v25, v205, v206
    v_mfma_f32_16x16x32_bf16 v[56:59], v[160:163], v[148:151], v[56:59]
    ds_read_b64_tr_b16 v[182:183], v31 offset:7680
    v_max3_u32 v25, v25, v207, v208
    v_mfma_f32_16x16x32_bf16 v[80:83], v[160:163], v[152:155], v[80:83]
    buffer_load_dwordx4 v2, s[8:11], s71 offen offset:0 sc1 lds
    v_mfma_f32_16x16x32_bf16 v[104:107], v[160:163], v[156:159], v[104:107]
    buffer_load_dwordx4 v2, s[8:11], s71 offen offset:1024 sc1 lds
    v_mfma_f32_16x16x32_bf16 v[108:111], v[164:167], v[156:159], v[108:111]
    ds_read_b64_tr_b16 v[160:161], v28 offset:9216
    v_max3_u32 v25, v25, v209, v210
    v_mfma_f32_16x16x32_bf16 v[84:87], v[164:167], v[152:155], v[84:87]
    ds_read_b64_tr_b16 v[162:163], v28 offset:10752
    v_max3_u32 v25, v25, v211, v212
    v_mfma_f32_16x16x32_bf16 v[60:63], v[164:167], v[148:151], v[60:63]
    buffer_load_dwordx4 v2, s[8:11], s71 offen offset:2048 sc1 lds
    v_mfma_f32_16x16x32_bf16 v[36:39], v[164:167], v[144:147], v[36:39]
    buffer_load_dwordx4 v2, s[8:11], s71 offen offset:3072 sc1 lds
    v_mfma_f32_16x16x32_bf16 v[40:43], v[168:171], v[144:147], v[40:43]
    ds_read_b64_tr_b16 v[164:165], v30 offset:9216
    v_max3_u32 v25, v25, v213, v214
    v_mfma_f32_16x16x32_bf16 v[64:67], v[168:171], v[148:151], v[64:67]
    ds_read_b64_tr_b16 v[166:167], v30 offset:10752
    v_max3_u32 v25, v25, v215, v216
    v_mfma_f32_16x16x32_bf16 v[88:91], v[168:171], v[152:155], v[88:91]
    s_waitcnt vmcnt(4)
    ds_read_b64_tr_b16 v[128:129], v4 offset:0
    v_mfma_f32_16x16x32_bf16 v[112:115], v[168:171], v[156:159], v[112:115]
    ds_read_b64_tr_b16 v[130:131], v4 offset:2048
    v_mfma_f32_16x16x32_bf16 v[116:119], v[172:175], v[156:159], v[116:119]
    ds_read_b64_tr_b16 v[168:169], v28 offset:9248
    ds_read_b64_tr_b16 v[132:133], v5 offset:0
    v_mfma_f32_16x16x32_bf16 v[92:95], v[172:175], v[152:155], v[92:95]
    ds_read_b64_tr_b16 v[170:171], v28 offset:10784
    ds_read_b64_tr_b16 v[134:135], v5 offset:2048
    v_mfma_f32_16x16x32_bf16 v[68:71], v[172:175], v[148:151], v[68:71]
    ds_read_b64_tr_b16 v[136:137], v6 offset:0
    v_mfma_f32_16x16x32_bf16 v[44:47], v[172:175], v[144:147], v[44:47]
    ds_read_b64_tr_b16 v[138:139], v6 offset:2048
    s_waitcnt lgkmcnt(12)
    v_mfma_f32_16x16x32_bf16 v[48:51], v[176:179], v[144:147], v[48:51]
    ds_read_b64_tr_b16 v[172:173], v30 offset:9248
    ds_read_b64_tr_b16 v[140:141], v7 offset:0
    v_mfma_f32_16x16x32_bf16 v[72:75], v[176:179], v[148:151], v[72:75]
    ds_read_b64_tr_b16 v[174:175], v30 offset:10784
    ds_read_b64_tr_b16 v[142:143], v7 offset:2048
    v_mfma_f32_16x16x32_bf16 v[96:99], v[176:179], v[152:155], v[96:99]
    v_max3_u32 v25, v25, v217, v218
    v_max3_u32 v25, v25, v219, v220
    v_mfma_f32_16x16x32_bf16 v[120:123], v[176:179], v[156:159], v[120:123]
    v_max3_u32 v25, v25, v221, v222
    v_max_u32 v25, v25, v223
    v_mfma_f32_16x16x32_bf16 v[124:127], v[180:183], v[156:159], v[124:127]
    ds_read_b64_tr_b16 v[176:177], v29 offset:9216
    v_cmp_eq_u32 vcc, -1, v25
    s_cbranch_vccz L_stok
    s_mov_b32 s79, 0
Lpoll_57:
    buffer_load_dwordx4 v[192:195], v24, s[8:11], s45 offen sc1
    buffer_load_dwordx4 v[196:199], v24, s[8:11], s45 offen offset:16 sc1
    buffer_load_dwordx4 v[200:203], v24, s[8:11], s46 offen sc1
    buffer_load_dwordx4 v[204:207], v24, s[8:11], s46 offen offset:16 sc1
    buffer_load_dwordx4 v[208:211], v24, s[8:11], s47 offen sc1
    buffer_load_dwordx4 v[212:215], v24, s[8:11], s47 offen offset:16 sc1
    buffer_load_dwordx4 v[216:219], v24, s[8:11], s48 offen sc1
    buffer_load_dwordx4 v[220:223], v24, s[8:11], s48 offen offset:16 sc1
    s_waitcnt vmcnt(0)
    v_max3_u32 v25, v192, v193, v194
    v_max3_u32 v25, v25, v195, v196
    v_max3_u32 v25, v25, v197, v198
    v_max3_u32 v25, v25, v199, v200
    v_max3_u32 v25, v25, v201, v202
    v_max3_u32 v25, v25, v203, v204
    v_max3_u32 v25, v25, v205, v206
    v_max3_u32 v25, v25, v207, v208
    v_max3_u32 v25, v25, v209, v210
    v_max3_u32 v25, v25, v211, v212
    v_max3_u32 v25, v25, v213, v214
    v_max3_u32 v25, v25, v215, v216
    v_max3_u32 v25, v25, v217, v218
    v_max3_u32 v25, v25, v219, v220
    v_max3_u32 v25, v25, v221, v222
    v_max_u32 v25, v25, v223
    v_cmp_eq_u32 vcc, -1, v25
    s_cbranch_vccz Lpd_58
    s_add_u32 s79, s79, 1
    s_cmp_lt_u32 s79, s80
    s_cbranch_scc1 Lpoll_57
    s_mov_b32 s80, 0
Lpd_58:
L_stok:
    v_mfma_f32_16x16x32_bf16 v[100:103], v[180:183], v[152:155], v[100:103]
    ds_read_b64_tr_b16 v[178:179], v29 offset:10752
    v_add_f32 v192, v192, v193
    v_mfma_f32_16x16x32_bf16 v[76:79], v[180:183], v[148:151], v[76:79]
    v_add_f32 v196, v196, v197
    v_add_f32 v200, v200, v201
    v_mfma_f32_16x16x32_bf16 v[52:55], v[180:183], v[144:147], v[52:55]
    v_add_f32 v204, v204, v205
    v_add_f32 v208, v208, v209
    s_waitcnt lgkmcnt(2)
    v_mfma_f32_16x16x32_bf16 v[32:35], v[160:163], v[128:131], v[32:35]
    ds_read_b64_tr_b16 v[180:181], v31 offset:9216
    v_add_f32 v212, v212, v213
    v_mfma_f32_16x16x32_bf16 v[56:59], v[160:163], v[132:135], v[56:59]
    ds_read_b64_tr_b16 v[182:183], v31 offset:10752
    v_add_f32 v216, v216, v217
    v_mfma_f32_16x16x32_bf16 v[80:83], v[160:163], v[136:139], v[80:83]
    v_add_f32 v220, v220, v221
    v_add_f32 v192, v192, v194
    v_mfma_f32_16x16x32_bf16 v[104:107], v[160:163], v[140:143], v[104:107]
    v_add_f32 v196, v196, v198
    v_add_f32 v200, v200, v202
    v_mfma_f32_16x16x32_bf16 v[108:111], v[164:167], v[140:143], v[108:111]
    ds_read_b64_tr_b16 v[160:161], v28 offset:12288
    v_add_f32 v204, v204, v206
    v_mfma_f32_16x16x32_bf16 v[84:87], v[164:167], v[136:139], v[84:87]
    ds_read_b64_tr_b16 v[162:163], v28 offset:13824
    v_add_f32 v208, v208, v210
    v_mfma_f32_16x16x32_bf16 v[60:63], v[164:167], v[132:135], v[60:63]
    v_add_f32 v212, v212, v214
    v_add_f32 v216, v216, v218
    v_mfma_f32_16x16x32_bf16 v[36:39], v[164:167], v[128:131], v[36:39]
    v_add_f32 v220, v220, v222
    v_add_f32 v192, v192, v195
    v_mfma_f32_16x16x32_bf16 v[40:43], v[168:171], v[128:131], v[40:43]
    ds_read_b64_tr_b16 v[164:165], v30 offset:12288
    v_add_f32 v196, v196, v199
    v_mfma_f32_16x16x32_bf16 v[64:67], v[168:171], v[132:135], v[64:67]
    ds_read_b64_tr_b16 v[166:167], v30 offset:13824
    v_add_f32 v200, v200, v203
    v_mfma_f32_16x16x32_bf16 v[88:91], v[168:171], v[136:139], v[88:91]
    s_waitcnt vmcnt(0)
    ds_read_b64_tr_b16 v[144:145], v4 offset:4096
    v_mfma_f32_16x16x32_bf16 v[112:115], v[168:171], v[140:143], v[112:115]
    ds_read_b64_tr_b16 v[146:147], v4 offset:6144
    s_cmp_lg_u32 s12, 1
    s_cbranch_scc1 Ltc_59
    s_cmp_lg_u32 s13, 0
    s_cbranch_scc1 Ltc_59
    s_mov_b32 s76, 1024
    buffer_load_dword v19, v27, s[8:11], s76 offen sc1
    v_min_u32 v8, 19, v1
    s_mul_i32 s76, s3, 2560
    v_lshlrev_b32 v8, 7, v8
    s_add_u32 s76, s76, s43
    s_add_u32 s76, s76, 10485760
Ltc_59:
    v_mfma_f32_16x16x32_bf16 v[116:119], v[172:175], v[140:143], v[116:119]
    ds_read_b64_tr_b16 v[168:169], v28 offset:12320
    ds_read_b64_tr_b16 v[148:149], v5 offset:4096
    v_mfma_f32_16x16x32_bf16 v[92:95], v[172:175], v[136:139], v[92:95]
    ds_read_b64_tr_b16 v[170:171], v28 offset:13856
    ds_read_b64_tr_b16 v[150:151], v5 offset:6144
    v_mfma_f32_16x16x32_bf16 v[68:71], v[172:175], v[132:135], v[68:71]
    ds_read_b64_tr_b16 v[152:153], v6 offset:4096
    v_mfma_f32_16x16x32_bf16 v[44:47], v[172:175], v[128:131], v[44:47]
    ds_read_b64_tr_b16 v[154:155], v6 offset:6144
    s_waitcnt lgkmcnt(12)
    v_mfma_f32_16x16x32_bf16 v[48:51], v[176:179], v[128:131], v[48:51]
    ds_read_b64_tr_b16 v[172:173], v30 offset:12320
    ds_read_b64_tr_b16 v[156:157], v7 offset:4096
    v_mfma_f32_16x16x32_bf16 v[72:75], v[176:179], v[132:135], v[72:75]
    ds_read_b64_tr_b16 v[174:175], v30 offset:13856
    ds_read_b64_tr_b16 v[158:159], v7 offset:6144
    v_mfma_f32_16x16x32_bf16 v[96:99], v[176:179], v[136:139], v[96:99]
    v_add_f32 v204, v204, v207
    v_add_f32 v208, v208, v211
    v_mfma_f32_16x16x32_bf16 v[120:123], v[176:179], v[140:143], v[120:123]
    v_add_f32 v212, v212, v215
    v_add_f32 v216, v216, v219
    v_mfma_f32_16x16x32_bf16 v[124:127], v[180:183], v[140:143], v[124:127]
    ds_read_b64_tr_b16 v[176:177], v29 offset:12288
    v_add_f32 v220, v220, v223
    v_mfma_f32_16x16x32_bf16 v[100:103], v[180:183], v[136:139], v[100:103]
    ds_read_b64_tr_b16 v[178:179], v29 offset:13824
    v_mul_f32 v184, 0xbacccccd, v196
    v_mfma_f32_16x16x32_bf16 v[76:79], v[180:183], v[132:135], v[76:79]
    v_mul_f32 v192, 0x3acccccd, v192
    v_mfma_f32_16x16x32_bf16 v[52:55], v[180:183], v[128:131], v[52:55]
    v_mul_f32 v188, 0xbacccccd, v204
    v_mul_f32 v200, 0x3acccccd, v200
    s_waitcnt lgkmcnt(2)
    v_mfma_f32_16x16x32_bf16 v[32:35], v[160:163], v[144:147], v[32:35]
    ds_read_b64_tr_b16 v[180:181], v31 offset:12288
    v_mul_f32 v248, 0xbacccccd, v212
    v_mul_f32 v208, 0x3acccccd, v208
    v_mfma_f32_16x16x32_bf16 v[56:59], v[160:163], v[148:151], v[56:59]
    ds_read_b64_tr_b16 v[182:183], v31 offset:13824
    v_mul_f32 v252, 0xbacccccd, v220
    v_mul_f32 v216, 0x3acccccd, v216
    v_mfma_f32_16x16x32_bf16 v[80:83], v[160:163], v[152:155], v[80:83]
    s_add_u32 s76, s51, 0
    s_cmp_lt_u32 s76, 10240
    s_cselect_b32 s77, s65, s42
    s_add_u32 s77, s77, s76
    s_add_u32 m0, s76, 143360
    s_nop 0
    buffer_load_dwordx4 v3, s[8:11], s77 offen sc1 lds
    v_fma_f32 v192, -v184, v184, v192
    v_fma_f32 v200, -v188, v188, v200
    v_mfma_f32_16x16x32_bf16 v[104:107], v[160:163], v[156:159], v[104:107]
    v_fma_f32 v208, -v248, v248, v208
    v_fma_f32 v216, -v252, v252, v216
    v_mfma_f32_16x16x32_bf16 v[108:111], v[164:167], v[156:159], v[108:111]
    s_add_u32 s76, s51, 1024
    s_cmp_lt_u32 s76, 10240
    s_cselect_b32 s77, s65, s42
    s_add_u32 s77, s77, s76
    s_add_u32 m0, s76, 143360
    s_nop 0
    buffer_load_dwordx4 v3, s[8:11], s77 offen sc1 lds
    v_max_f32 v192, 0, v192
    v_max_f32 v200, 0, v200
    v_mfma_f32_16x16x32_bf16 v[84:87], v[164:167], v[152:155], v[84:87]
    v_max_f32 v208, 0, v208
    v_max_f32 v216, 0, v216
    v_mfma_f32_16x16x32_bf16 v[60:63], v[164:167], v[148:151], v[60:63]
    s_add_u32 s76, s51, 2048
    s_cmp_lt_u32 s76, 10240
    s_cselect_b32 s77, s65, s42
    s_add_u32 s77, s77, s76
    s_add_u32 m0, s76, 143360
    s_nop 0
    buffer_load_dwordx4 v3, s[8:11], s77 offen sc1 lds
    v_add_f32 v185, 0x3727c5ac, v192
    v_add_f32 v189, 0x3727c5ac, v200
    v_mfma_f32_16x16x32_bf16 v[36:39], v[164:167], v[144:147], v[36:39]
    v_add_f32 v249, 0x3727c5ac, v208
    v_add_f32 v253, 0x3727c5ac, v216
    v_mfma_f32_16x16x32_bf16 v[40:43], v[168:171], v[144:147], v[40:43]
    s_add_u32 s76, s51, 3072
    s_cmp_lt_u32 s76, 10240
    s_cselect_b32 s77, s65, s42
    s_add_u32 s77, s77, s76
    s_add_u32 m0, s76, 143360
    s_nop 0
    buffer_load_dwordx4 v3, s[8:11], s77 offen sc1 lds
    v_rsq_f32 v192, v185
    v_rsq_f32 v200, v189
    v_mfma_f32_16x16x32_bf16 v[64:67], v[168:171], v[148:151], v[64:67]
    v_rsq_f32 v208, v249
    v_rsq_f32 v216, v253
    v_mfma_f32_16x16x32_bf16 v[88:91], v[168:171], v[152:155], v[88:91]
    v_mul_f32 v186, 0xc0135761, v192
    v_mul_f32 v193, v192, v192
    v_mfma_f32_16x16x32_bf16 v[112:115], v[168:171], v[156:159], v[112:115]
    s_cmp_lg_u32 s3, 3
    s_cbranch_scc1 Lmore_60
    s_add_u32 s76, s51, 4096
    s_cmp_lt_u32 s76, 10240
    s_cselect_b32 s77, s65, s42
    s_add_u32 s77, s77, s76
    s_add_u32 m0, s76, 143360
    s_nop 0
    buffer_load_dwordx4 v3, s[8:11], s77 offen sc1 lds
    s_add_u32 s76, s51, 5120
    s_cmp_lt_u32 s76, 10240
    s_cselect_b32 s77, s65, s42
    s_add_u32 s77, s77, s76
    s_add_u32 m0, s76, 143360
    s_nop 0
    buffer_load_dwordx4 v3, s[8:11], s77 offen sc1 lds
    s_add_u32 s76, s51, 6144
    s_cmp_lt_u32 s76, 10240
    s_cselect_b32 s77, s65, s42
    s_add_u32 s77, s77, s76
    s_add_u32 m0, s76, 143360
    s_nop 0
    buffer_load_dwordx4 v3, s[8:11], s77 offen sc1 lds
    s_add_u32 s76, s51, 7168
    s_cmp_lt_u32 s76, 10240
    s_cselect_b32 s77, s65, s42
    s_add_u32 s77, s77, s76
    s_add_u32 m0, s76, 143360
    s_nop 0
    buffer_load_dwordx4 v3, s[8:11], s77 offen sc1 lds
Lmore_60:
    v_mul_f32 v190, 0xc0135761, v200
    v_mul_f32 v201, v200, v200
    v_mfma_f32_16x16x32_bf16 v[116:119], v[172:175], v[156:159], v[116:119]
    v_mul_f32 v250, 0xc0135761, v208
    v_mul_f32 v209, v208, v208
    v_mfma_f32_16x16x32_bf16 v[92:95], v[172:175], v[152:155], v[92:95]
    v_mul_f32 v254, 0xc0135761, v216
    v_mul_f32 v217, v216, v216
    v_mfma_f32_16x16x32_bf16 v[68:71], v[172:175], v[148:151], v[68:71]
    v_mul_f32 v193, 0x3d372713, v193
    v_mul_f32 v201, 0x3d372713, v201
    v_mfma_f32_16x16x32_bf16 v[44:47], v[172:175], v[144:147], v[44:47]
    v_mul_f32 v209, 0x3d372713, v209
    v_mul_f32 v217, 0x3d372713, v217
    s_waitcnt lgkmcnt(0)
    v_mfma_f32_16x16x32_bf16 v[48:51], v[176:179], v[144:147], v[48:51]
    v_mul_f32 v187, v186, v193
    v_mul_f32 v191, v190, v201
    v_mfma_f32_16x16x32_bf16 v[72:75], v[176:179], v[148:151], v[72:75]
    v_mul_f32 v251, v250, v209
    v_mul_f32 v255, v254, v217
    v_mfma_f32_16x16x32_bf16 v[96:99], v[176:179], v[152:155], v[96:99]
    v_mfma_f32_16x16x32_bf16 v[120:123], v[176:179], v[156:159], v[120:123]
    v_mfma_f32_16x16x32_bf16 v[124:127], v[180:183], v[156:159], v[124:127]
    v_mfma_f32_16x16x32_bf16 v[100:103], v[180:183], v[152:155], v[100:103]
    v_mfma_f32_16x16x32_bf16 v[76:79], v[180:183], v[148:151], v[76:79]
    v_mfma_f32_16x16x32_bf16 v[52:55], v[180:183], v[144:147], v[52:55]
    v_mov_b32 v2, v20
    v_and_b32 v12, 7, v1
    v_lshlrev_b32 v12, 2, v12
L_ep0:
    v_pk_fma_f32 v[32:33], v[184:185], v[224:225], v[32:33] op_sel_hi:[0,1,1]
    v_pk_fma_f32 v[34:35], v[184:185], v[226:227], v[34:35] op_sel_hi:[0,1,1]
    v_pk_fma_f32 v[40:41], v[184:185], v[232:233], v[40:41] op_sel_hi:[0,1,1]
    v_pk_fma_f32 v[42:43], v[184:185], v[234:235], v[42:43] op_sel_hi:[0,1,1]
    v_pk_fma_f32 v[48:49], v[184:185], v[240:241], v[48:49] op_sel_hi:[0,1,1]
    v_pk_fma_f32 v[50:51], v[184:185], v[242:243], v[50:51] op_sel_hi:[0,1,1]
    v_pk_mul_f32 v[144:145], v[32:33], v[32:33]
    v_pk_mul_f32 v[146:147], v[34:35], v[34:35]
    v_pk_mul_f32 v[148:149], v[40:41], v[40:41]
    v_pk_mul_f32 v[150:151], v[42:43], v[42:43]
    v_pk_mul_f32 v[152:153], v[48:49], v[48:49]
    v_pk_mul_f32 v[154:155], v[50:51], v[50:51]
    v_pk_fma_f32 v[144:145], v[144:145], v[186:187], v[186:187] op_sel:[0,1,0] op_sel_hi:[1,1,0]
    v_pk_fma_f32 v[146:147], v[146:147], v[186:187], v[186:187] op_sel:[0,1,0] op_sel_hi:[1,1,0]
    v_pk_fma_f32 v[148:149], v[148:149], v[186:187], v[186:187] op_sel:[0,1,0] op_sel_hi:[1,1,0]
    v_pk_fma_f32 v[150:151], v[150:151], v[186:187], v[186:187] op_sel:[0,1,0] op_sel_hi:[1,1,0]
    v_pk_fma_f32 v[152:153], v[152:153], v[186:187], v[186:187] op_sel:[0,1,0] op_sel_hi:[1,1,0]
    v_pk_fma_f32 v[154:155], v[154:155], v[186:187], v[186:187] op_sel:[0,1,0] op_sel_hi:[1,1,0]
    v_pk_mul_f32 v[144:145], v[144:145], v[32:33]
    v_pk_mul_f32 v[146:147], v[146:147], v[34:35]
    v_pk_mul_f32 v[148:149], v[148:149], v[40:41]
    v_pk_mul_f32 v[150:151], v[150:151], v[42:43]
    v_pk_mul_f32 v[152:153], v[152:153], v[48:49]
    v_pk_mul_f32 v[154:155], v[154:155], v[50:51]
    v_exp_f32 v144, v144
    v_exp_f32 v145, v145
    v_pk_fma_f32 v[36:37], v[184:185], v[228:229], v[36:37] op_sel_hi:[0,1,1]
    v_exp_f32 v146, v146
    v_exp_f32 v147, v147
    v_pk_fma_f32 v[38:39], v[184:185], v[230:231], v[38:39] op_sel_hi:[0,1,1]
    v_exp_f32 v148, v148
    v_exp_f32 v149, v149
    v_pk_fma_f32 v[44:45], v[184:185], v[236:237], v[44:45] op_sel_hi:[0,1,1]
    v_exp_f32 v150, v150
    v_exp_f32 v151, v151
    v_pk_fma_f32 v[46:47], v[184:185], v[238:239], v[46:47] op_sel_hi:[0,1,1]
    v_exp_f32 v152, v152
    v_exp_f32 v153, v153
    v_pk_fma_f32 v[52:53], v[184:185], v[244:245], v[52:53] op_sel_hi:[0,1,1]
    v_exp_f32 v154, v154
    v_exp_f32 v155, v155
    v_pk_fma_f32 v[54:55], v[184:185], v[246:247], v[54:55] op_sel_hi:[0,1,1]
    v_pk_fma_f32 v[144:145], v[144:145], v[184:185], v[184:185] op_sel:[0,1,1] op_sel_hi:[1,1,1]
    v_pk_fma_f32 v[146:147], v[146:147], v[184:185], v[184:185] op_sel:[0,1,1] op_sel_hi:[1,1,1]
    v_pk_fma_f32 v[148:149], v[148:149], v[184:185], v[184:185] op_sel:[0,1,1] op_sel_hi:[1,1,1]
    v_pk_fma_f32 v[150:151], v[150:151], v[184:185], v[184:185] op_sel:[0,1,1] op_sel_hi:[1,1,1]
    v_pk_fma_f32 v[152:153], v[152:153], v[184:185], v[184:185] op_sel:[0,1,1] op_sel_hi:[1,1,1]
    v_pk_fma_f32 v[154:155], v[154:155], v[184:185], v[184:185] op_sel:[0,1,1] op_sel_hi:[1,1,1]
    v_rcp_f32 v144, v144
    v_rcp_f32 v145, v145
    v_pk_mul_f32 v[32:33], v[32:33], v[36:37]
    v_rcp_f32 v146, v146
    v_rcp_f32 v147, v147
    v_pk_mul_f32 v[34:35], v[34:35], v[38:39]
    v_rcp_f32 v148, v148
    v_rcp_f32 v149, v149
    v_pk_mul_f32 v[40:41], v[40:41], v[44:45]
    v_rcp_f32 v150, v150
    v_rcp_f32 v151, v151
    v_pk_mul_f32 v[42:43], v[42:43], v[46:47]
    v_rcp_f32 v152, v152
    v_rcp_f32 v153, v153
    v_pk_mul_f32 v[48:49], v[48:49], v[52:53]
    v_rcp_f32 v154, v154
    v_rcp_f32 v155, v155
    v_pk_mul_f32 v[50:51], v[50:51], v[54:55]
    v_pk_mul_f32 v[32:33], v[32:33], v[144:145]
    v_pk_mul_f32 v[34:35], v[34:35], v[146:147]
    v_pk_mul_f32 v[40:41], v[40:41], v[148:149]
    v_pk_mul_f32 v[42:43], v[42:43], v[150:151]
    v_pk_mul_f32 v[48:49], v[48:49], v[152:153]
    v_pk_mul_f32 v[50:51], v[50:51], v[154:155]
    v_cvt_pk_bf16_f32 v192, v32, v33
    v_cvt_pk_bf16_f32 v193, v34, v35
    v_cvt_pk_bf16_f32 v194, v40, v41
    v_cvt_pk_bf16_f32 v195, v42, v43
    v_cvt_pk_bf16_f32 v196, v48, v49
    v_cvt_pk_bf16_f32 v197, v50, v51
    s_add_u32 s78, s52, s56
    s_cmp_eq_u32 s12, 1
    s_cbranch_scc1 Lf_61
    buffer_store_dwordx4 v[192:195], v2, s[8:11], s78 offen sc1
    buffer_store_dwordx2 v[196:197], v21, s[8:11], s52 offen offset:1024 sc1
    s_branch Lg_62
Lf_61:
    buffer_store_dwordx4 v[192:195], v2, s[8:11], s78 offen
    buffer_store_dwordx2 v[196:197], v21, s[8:11], s52 offen offset:1024
Lg_62:
L_ep1:
    v_pk_fma_f32 v[56:57], v[188:189], v[224:225], v[56:57] op_sel_hi:[0,1,1]
    v_pk_fma_f32 v[58:59], v[188:189], v[226:227], v[58:59] op_sel_hi:[0,1,1]
    v_pk_fma_f32 v[64:65], v[188:189], v[232:233], v[64:65] op_sel_hi:[0,1,1]
    v_pk_fma_f32 v[66:67], v[188:189], v[234:235], v[66:67] op_sel_hi:[0,1,1]
    v_pk_fma_f32 v[72:73], v[188:189], v[240:241], v[72:73] op_sel_hi:[0,1,1]
    v_pk_fma_f32 v[74:75], v[188:189], v[242:243], v[74:75] op_sel_hi:[0,1,1]
    v_pk_mul_f32 v[144:145], v[56:57], v[56:57]
    v_pk_mul_f32 v[146:147], v[58:59], v[58:59]
    v_pk_mul_f32 v[148:149], v[64:65], v[64:65]
    v_pk_mul_f32 v[150:151], v[66:67], v[66:67]
    v_pk_mul_f32 v[152:153], v[72:73], v[72:73]
    v_pk_mul_f32 v[154:155], v[74:75], v[74:75]
    v_pk_fma_f32 v[144:145], v[144:145], v[190:191], v[190:191] op_sel:[0,1,0] op_sel_hi:[1,1,0]
    v_pk_fma_f32 v[146:147], v[146:147], v[190:191], v[190:191] op_sel:[0,1,0] op_sel_hi:[1,1,0]
    v_pk_fma_f32 v[148:149], v[148:149], v[190:191], v[190:191] op_sel:[0,1,0] op_sel_hi:[1,1,0]
    v_pk_fma_f32 v[150:151], v[150:151], v[190:191], v[190:191] op_sel:[0,1,0] op_sel_hi:[1,1,0]
    v_pk_fma_f32 v[152:153], v[152:153], v[190:191], v[190:191] op_sel:[0,1,0] op_sel_hi:[1,1,0]
    v_pk_fma_f32 v[154:155], v[154:155], v[190:191], v[190:191] op_sel:[0,1,0] op_sel_hi:[1,1,0]
    v_pk_mul_f32 v[144:145], v[144:145], v[56:57]
    v_pk_mul_f32 v[146:147], v[146:147], v[58:59]
    v_pk_mul_f32 v[148:149], v[148:149], v[64:65]
    v_pk_mul_f32 v[150:151], v[150:151], v[66:67]
    v_pk_mul_f32 v[152:153], v[152:153], v[72:73]
    v_pk_mul_f32 v[154:155], v[154:155], v[74:75]
    v_exp_f32 v144, v144
    v_exp_f32 v145, v145
    v_pk_fma_f32 v[60:61], v[188:189], v[228:229], v[60:61] op_sel_hi:[0,1,1]
    v_exp_f32 v146, v146
    v_exp_f32 v147, v147
    v_pk_fma_f32 v[62:63], v[188:189], v[230:231], v[62:63] op_sel_hi:[0,1,1]
    v_exp_f32 v148, v148
    v_exp_f32 v149, v149
    v_pk_fma_f32 v[68:69], v[188:189], v[236:237], v[68:69] op_sel_hi:[0,1,1]
    v_exp_f32 v150, v150
    v_exp_f32 v151, v151
    v_pk_fma_f32 v[70:71], v[188:189], v[238:239], v[70:71] op_sel_hi:[0,1,1]
    v_exp_f32 v152, v152
    v_exp_f32 v153, v153
    v_pk_fma_f32 v[76:77], v[188:189], v[244:245], v[76:77] op_sel_hi:[0,1,1]
    v_exp_f32 v154, v154
    v_exp_f32 v155, v155
    v_pk_fma_f32 v[78:79], v[188:189], v[246:247], v[78:79] op_sel_hi:[0,1,1]
    v_pk_fma_f32 v[144:145], v[144:145], v[188:189], v[188:189] op_sel:[0,1,1] op_sel_hi:[1,1,1]
    v_pk_fma_f32 v[146:147], v[146:147], v[188:189], v[188:189] op_sel:[0,1,1] op_sel_hi:[1,1,1]
    v_pk_fma_f32 v[148:149], v[148:149], v[188:189], v[188:189] op_sel:[0,1,1] op_sel_hi:[1,1,1]
    v_pk_fma_f32 v[150:151], v[150:151], v[188:189], v[188:189] op_sel:[0,1,1] op_sel_hi:[1,1,1]
    v_pk_fma_f32 v[152:153], v[152:153], v[188:189], v[188:189] op_sel:[0,1,1] op_sel_hi:[1,1,1]
    v_pk_fma_f32 v[154:155], v[154:155], v[188:189], v[188:189] op_sel:[0,1,1] op_sel_hi:[1,1,1]
    v_rcp_f32 v144, v144
    v_rcp_f32 v145, v145
    v_pk_mul_f32 v[56:57], v[56:57], v[60:61]
    v_rcp_f32 v146, v146
    v_rcp_f32 v147, v147
    v_pk_mul_f32 v[58:59], v[58:59], v[62:63]
    v_rcp_f32 v148, v148
    v_rcp_f32 v149, v149
    v_pk_mul_f32 v[64:65], v[64:65], v[68:69]
    v_rcp_f32 v150, v150
    v_rcp_f32 v151, v151
    v_pk_mul_f32 v[66:67], v[66:67], v[70:71]
    v_rcp_f32 v152, v152
    v_rcp_f32 v153, v153
    v_pk_mul_f32 v[72:73], v[72:73], v[76:77]
    v_rcp_f32 v154, v154
    v_rcp_f32 v155, v155
    v_pk_mul_f32 v[74:75], v[74:75], v[78:79]
    v_pk_mul_f32 v[56:57], v[56:57], v[144:145]
    v_pk_mul_f32 v[58:59], v[58:59], v[146:147]
    v_pk_mul_f32 v[64:65], v[64:65], v[148:149]
    v_pk_mul_f32 v[66:67], v[66:67], v[150:151]
    v_pk_mul_f32 v[72:73], v[72:73], v[152:153]
    v_pk_mul_f32 v[74:75], v[74:75], v[154:155]
    v_cvt_pk_bf16_f32 v200, v56, v57
    v_cvt_pk_bf16_f32 v201, v58, v59
    v_cvt_pk_bf16_f32 v202, v64, v65
    v_cvt_pk_bf16_f32 v203, v66, v67
    v_cvt_pk_bf16_f32 v204, v72, v73
    v_cvt_pk_bf16_f32 v205, v74, v75
    s_add_u32 s78, s53, s56
    s_cmp_eq_u32 s12, 1
    s_cbranch_scc1 Lf_63
    buffer_store_dwordx4 v[200:203], v2, s[8:11], s78 offen sc1
    buffer_store_dwordx2 v[204:205], v21, s[8:11], s53 offen offset:1024 sc1
    s_branch Lg_64
Lf_63:
    buffer_store_dwordx4 v[200:203], v2, s[8:11], s78 offen
    buffer_store_dwordx2 v[204:205], v21, s[8:11], s53 offen offset:1024
Lg_64:
L_ep2:
    v_pk_fma_f32 v[80:81], v[248:249], v[224:225], v[80:81] op_sel_hi:[0,1,1]
    v_pk_fma_f32 v[82:83], v[248:249], v[226:227], v[82:83] op_sel_hi:[0,1,1]
    v_pk_fma_f32 v[88:89], v[248:249], v[232:233], v[88:89] op_sel_hi:[0,1,1]
    v_pk_fma_f32 v[90:91], v[248:249], v[234:235], v[90:91] op_sel_hi:[0,1,1]
    v_pk_fma_f32 v[96:97], v[248:249], v[240:241], v[96:97] op_sel_hi:[0,1,1]
    v_pk_fma_f32 v[98:99], v[248:249], v[242:243], v[98:99] op_sel_hi:[0,1,1]
    v_pk_mul_f32 v[144:145], v[80:81], v[80:81]
    v_pk_mul_f32 v[146:147], v[82:83], v[82:83]
    v_pk_mul_f32 v[148:149], v[88:89], v[88:89]
    v_pk_mul_f32 v[150:151], v[90:91], v[90:91]
    v_pk_mul_f32 v[152:153], v[96:97], v[96:97]
    v_pk_mul_f32 v[154:155], v[98:99], v[98:99]
    v_pk_fma_f32 v[144:145], v[144:145], v[250:251], v[250:251] op_sel:[0,1,0] op_sel_hi:[1,1,0]
    v_pk_fma_f32 v[146:147], v[146:147], v[250:251], v[250:251] op_sel:[0,1,0] op_sel_hi:[1,1,0]
    v_pk_fma_f32 v[148:149], v[148:149], v[250:251], v[250:251] op_sel:[0,1,0] op_sel_hi:[1,1,0]
    v_pk_fma_f32 v[150:151], v[150:151], v[250:251], v[250:251] op_sel:[0,1,0] op_sel_hi:[1,1,0]
    v_pk_fma_f32 v[152:153], v[152:153], v[250:251], v[250:251] op_sel:[0,1,0] op_sel_hi:[1,1,0]
    v_pk_fma_f32 v[154:155], v[154:155], v[250:251], v[250:251] op_sel:[0,1,0] op_sel_hi:[1,1,0]
    v_pk_mul_f32 v[144:145], v[144:145], v[80:81]
    v_pk_mul_f32 v[146:147], v[146:147], v[82:83]
    v_pk_mul_f32 v[148:149], v[148:149], v[88:89]
    v_pk_mul_f32 v[150:151], v[150:151], v[90:91]
    v_pk_mul_f32 v[152:153], v[152:153], v[96:97]
    v_pk_mul_f32 v[154:155], v[154:155], v[98:99]
    v_exp_f32 v144, v144
    v_exp_f32 v145, v145
    v_pk_fma_f32 v[84:85], v[248:249], v[228:229], v[84:85] op_sel_hi:[0,1,1]
    v_exp_f32 v146, v146
    v_exp_f32 v147, v147
    v_pk_fma_f32 v[86:87], v[248:249], v[230:231], v[86:87] op_sel_hi:[0,1,1]
    v_exp_f32 v148, v148
    v_exp_f32 v149, v149
    v_pk_fma_f32 v[92:93], v[248:249], v[236:237], v[92:93] op_sel_hi:[0,1,1]
    v_exp_f32 v150, v150
    v_exp_f32 v151, v151
    v_pk_fma_f32 v[94:95], v[248:249], v[238:239], v[94:95] op_sel_hi:[0,1,1]
    v_exp_f32 v152, v152
    v_exp_f32 v153, v153
    v_pk_fma_f32 v[100:101], v[248:249], v[244:245], v[100:101] op_sel_hi:[0,1,1]
    v_exp_f32 v154, v154
    v_exp_f32 v155, v155
    v_pk_fma_f32 v[102:103], v[248:249], v[246:247], v[102:103] op_sel_hi:[0,1,1]
    v_pk_fma_f32 v[144:145], v[144:145], v[248:249], v[248:249] op_sel:[0,1,1] op_sel_hi:[1,1,1]
    v_pk_fma_f32 v[146:147], v[146:147], v[248:249], v[248:249] op_sel:[0,1,1] op_sel_hi:[1,1,1]
    v_pk_fma_f32 v[148:149], v[148:149], v[248:249], v[248:249] op_sel:[0,1,1] op_sel_hi:[1,1,1]
    v_pk_fma_f32 v[150:151], v[150:151], v[248:249], v[248:249] op_sel:[0,1,1] op_sel_hi:[1,1,1]
    v_pk_fma_f32 v[152:153], v[152:153], v[248:249], v[248:249] op_sel:[0,1,1] op_sel_hi:[1,1,1]
    v_pk_fma_f32 v[154:155], v[154:155], v[248:249], v[248:249] op_sel:[0,1,1] op_sel_hi:[1,1,1]
    v_rcp_f32 v144, v144
    v_rcp_f32 v145, v145
    v_pk_mul_f32 v[80:81], v[80:81], v[84:85]
    v_rcp_f32 v146, v146
    v_rcp_f32 v147, v147
    v_pk_mul_f32 v[82:83], v[82:83], v[86:87]
    v_rcp_f32 v148, v148
    v_rcp_f32 v149, v149
    v_pk_mul_f32 v[88:89], v[88:89], v[92:93]
    v_rcp_f32 v150, v150
    v_rcp_f32 v151, v151
    v_pk_mul_f32 v[90:91], v[90:91], v[94:95]
    v_rcp_f32 v152, v152
    v_rcp_f32 v153, v153
    v_pk_mul_f32 v[96:97], v[96:97], v[100:101]
    v_rcp_f32 v154, v154
    v_rcp_f32 v155, v155
    v_pk_mul_f32 v[98:99], v[98:99], v[102:103]
    s_waitcnt vmcnt(0)
    s_add_u32 s76, s92, 2
    v_mov_b32 v16, s76
    v_mov_b32 v17, 0
    s_mov_b64 exec, 1
    s_cmp_eq_u32 s12, 1
    s_cbranch_scc1 Lf_65
    buffer_store_dword v16, v17, s[8:11], s58 offen sc1
    s_branch Lg_66
Lf_65:
    buffer_store_dword v16, v17, s[8:11], s58 offen
Lg_66:
    s_mov_b64 exec, -1
L_nofl:
    v_pk_mul_f32 v[80:81], v[80:81], v[144:145]
    v_pk_mul_f32 v[82:83], v[82:83], v[146:147]
    v_pk_mul_f32 v[88:89], v[88:89], v[148:149]
    v_pk_mul_f32 v[90:91], v[90:91], v[150:151]
    v_pk_mul_f32 v[96:97], v[96:97], v[152:153]
    v_pk_mul_f32 v[98:99], v[98:99], v[154:155]
    v_cvt_pk_bf16_f32 v192, v80, v81
    v_cvt_pk_bf16_f32 v193, v82, v83
    v_cvt_pk_bf16_f32 v194, v88, v89
    v_cvt_pk_bf16_f32 v195, v90, v91
    v_cvt_pk_bf16_f32 v196, v96, v97
    v_cvt_pk_bf16_f32 v197, v98, v99
    s_add_u32 s78, s54, s56
    s_cmp_eq_u32 s12, 1
    s_cbranch_scc1 Lf_67
    buffer_store_dwordx4 v[192:195], v2, s[8:11], s78 offen sc1
    buffer_store_dwordx2 v[196:197], v21, s[8:11], s54 offen offset:1024 sc1
    s_branch Lg_68
Lf_67:
    buffer_store_dwordx4 v[192:195], v2, s[8:11], s78 offen
    buffer_store_dwordx2 v[196:197], v21, s[8:11], s54 offen offset:1024
Lg_68:
L_ep3:
    v_pk_fma_f32 v[104:105], v[252:253], v[224:225], v[104:105] op_sel_hi:[0,1,1]
    v_pk_fma_f32 v[106:107], v[252:253], v[226:227], v[106:107] op_sel_hi:[0,1,1]
    v_pk_fma_f32 v[112:113], v[252:253], v[232:233], v[112:113] op_sel_hi:[0,1,1]
    v_pk_fma_f32 v[114:115], v[252:253], v[234:235], v[114:115] op_sel_hi:[0,1,1]
    v_pk_fma_f32 v[120:121], v[252:253], v[240:241], v[120:121] op_sel_hi:[0,1,1]
    v_pk_fma_f32 v[122:123], v[252:253], v[242:243], v[122:123] op_sel_hi:[0,1,1]
    v_pk_mul_f32 v[144:145], v[104:105], v[104:105]
    v_pk_mul_f32 v[146:147], v[106:107], v[106:107]
    v_pk_mul_f32 v[148:149], v[112:113], v[112:113]
    v_pk_mul_f32 v[150:151], v[114:115], v[114:115]
    v_pk_mul_f32 v[152:153], v[120:121], v[120:121]
    v_pk_mul_f32 v[154:155], v[122:123], v[122:123]
    v_pk_fma_f32 v[144:145], v[144:145], v[254:255], v[254:255] op_sel:[0,1,0] op_sel_hi:[1,1,0]
    v_pk_fma_f32 v[146:147], v[146:147], v[254:255], v[254:255] op_sel:[0,1,0] op_sel_hi:[1,1,0]
    v_pk_fma_f32 v[148:149], v[148:149], v[254:255], v[254:255] op_sel:[0,1,0] op_sel_hi:[1,1,0]
    v_pk_fma_f32 v[150:151], v[150:151], v[254:255], v[254:255] op_sel:[0,1,0] op_sel_hi:[1,1,0]
    v_pk_fma_f32 v[152:153], v[152:153], v[254:255], v[254:255] op_sel:[0,1,0] op_sel_hi:[1,1,0]
    v_pk_fma_f32 v[154:155], v[154:155], v[254:255], v[254:255] op_sel:[0,1,0] op_sel_hi:[1,1,0]
    v_pk_mul_f32 v[144:145], v[144:145], v[104:105]
    v_pk_mul_f32 v[146:147], v[146:147], v[106:107]
    v_pk_mul_f32 v[148:149], v[148:149], v[112:113]
    v_pk_mul_f32 v[150:151], v[150:151], v[114:115]
    v_pk_mul_f32 v[152:153], v[152:153], v[120:121]
    v_pk_mul_f32 v[154:155], v[154:155], v[122:123]
    v_exp_f32 v144, v144
    v_exp_f32 v145, v145
    v_pk_fma_f32 v[108:109], v[252:253], v[228:229], v[108:109] op_sel_hi:[0,1,1]
    v_exp_f32 v146, v146
    v_exp_f32 v147, v147
    v_pk_fma_f32 v[110:111], v[252:253], v[230:231], v[110:111] op_sel_hi:[0,1,1]
    v_exp_f32 v148, v148
    v_exp_f32 v149, v149
    v_pk_fma_f32 v[116:117], v[252:253], v[236:237], v[116:117] op_sel_hi:[0,1,1]
    v_exp_f32 v150, v150
    v_exp_f32 v151, v151
    v_pk_fma_f32 v[118:119], v[252:253], v[238:239], v[118:119] op_sel_hi:[0,1,1]
    v_exp_f32 v152, v152
    v_exp_f32 v153, v153
    v_pk_fma_f32 v[124:125], v[252:253], v[244:245], v[124:125] op_sel_hi:[0,1,1]
    v_exp_f32 v154, v154
    v_exp_f32 v155, v155
    v_pk_fma_f32 v[126:127], v[252:253], v[246:247], v[126:127] op_sel_hi:[0,1,1]
    buffer_load_dword v13, v12, s[8:11], s57 offen sc1
L_nolk:
    v_pk_fma_f32 v[144:145], v[144:145], v[252:253], v[252:253] op_sel:[0,1,1] op_sel_hi:[1,1,1]
    v_pk_fma_f32 v[146:147], v[146:147], v[252:253], v[252:253] op_sel:[0,1,1] op_sel_hi:[1,1,1]
    v_pk_fma_f32 v[148:149], v[148:149], v[252:253], v[252:253] op_sel:[0,1,1] op_sel_hi:[1,1,1]
    v_pk_fma_f32 v[150:151], v[150:151], v[252:253], v[252:253] op_sel:[0,1,1] op_sel_hi:[1,1,1]
    v_pk_fma_f32 v[152:153], v[152:153], v[252:253], v[252:253] op_sel:[0,1,1] op_sel_hi:[1,1,1]
    v_pk_fma_f32 v[154:155], v[154:155], v[252:253], v[252:253] op_sel:[0,1,1] op_sel_hi:[1,1,1]
    v_rcp_f32 v144, v144
    v_rcp_f32 v145, v145
    v_pk_mul_f32 v[104:105], v[104:105], v[108:109]
    v_rcp_f32 v146, v146
    v_rcp_f32 v147, v147
    v_pk_mul_f32 v[106:107], v[106:107], v[110:111]
    v_rcp_f32 v148, v148
    v_rcp_f32 v149, v149
    v_pk_mul_f32 v[112:113], v[112:113], v[116:117]
    v_rcp_f32 v150, v150
    v_rcp_f32 v151, v151
    v_pk_mul_f32 v[114:115], v[114:115], v[118:119]
    v_rcp_f32 v152, v152
    v_rcp_f32 v153, v153
    v_pk_mul_f32 v[120:121], v[120:121], v[124:125]
    v_rcp_f32 v154, v154
    v_rcp_f32 v155, v155
    v_pk_mul_f32 v[122:123], v[122:123], v[126:127]
    v_pk_mul_f32 v[104:105], v[104:105], v[144:145]
    v_pk_mul_f32 v[106:107], v[106:107], v[146:147]
    v_pk_mul_f32 v[112:113], v[112:113], v[148:149]
    v_pk_mul_f32 v[114:115], v[114:115], v[150:151]
    v_pk_mul_f32 v[120:121], v[120:121], v[152:153]
    v_pk_mul_f32 v[122:123], v[122:123], v[154:155]
    v_cvt_pk_bf16_f32 v200, v104, v105
    v_cvt_pk_bf16_f32 v201, v106, v107
    v_cvt_pk_bf16_f32 v202, v112, v113
    v_cvt_pk_bf16_f32 v203, v114, v115
    v_cvt_pk_bf16_f32 v204, v120, v121
    v_cvt_pk_bf16_f32 v205, v122, v123
    s_add_u32 s78, s55, s56
    s_cmp_eq_u32 s12, 1
    s_cbranch_scc1 Lf_69
    buffer_store_dwordx4 v[200:203], v2, s[8:11], s78 offen sc1
    buffer_store_dwordx2 v[204:205], v21, s[8:11], s55 offen offset:1024 sc1
    s_branch Lg_70
Lf_69:
    buffer_store_dwordx4 v[200:203], v2, s[8:11], s78 offen
    buffer_store_dwordx2 v[204:205], v21, s[8:11], s55 offen offset:1024
Lg_70:
    s_waitcnt vmcnt(2)
    v_subrev_u32 v13, s92, v13
    v_add_u32 v13, -2, v13
    v_cmp_lt_u32 vcc, 7, v13
    s_cbranch_vccz L_hok1
    s_mov_b32 s79, 0
Lpoll_71:
    buffer_load_dword v13, v12, s[8:11], s57 offen sc1
    s_waitcnt vmcnt(0)
    v_subrev_u32 v13, s92, v13
    v_add_u32 v13, -2, v13
    v_cmp_lt_u32 vcc, 7, v13
    s_cbranch_vccz Lpd_72
    s_add_u32 s79, s79, 1
    s_cmp_lt_u32 s79, s80
    s_cbranch_scc1 Lpoll_71
    s_mov_b32 s80, 0
Lpd_72:
L_hok1:
    buffer_load_dwordx4 v[156:159], v2, s[8:11], s60 offen offset:0 sc1
    buffer_load_dwordx4 v[160:163], v2, s[8:11], s60 offen offset:1024 sc1
    buffer_load_dwordx4 v[164:167], v2, s[8:11], s60 offen offset:2048 sc1
    buffer_load_dwordx4 v[168:171], v2, s[8:11], s60 offen offset:3072 sc1
    s_add_u32 s60, s60, 4096
    buffer_load_dwordx4 v[172:175], v2, s[8:11], s60 offen offset:0 sc1
    buffer_load_dwordx4 v[176:179], v2, s[8:11], s60 offen offset:1024 sc1
    v_add_u32 v4, s26, v2
    v_add_u32 v5, s27, v2
    v_add_u32 v6, s28, v2
    v_add_u32 v7, s29, v2
    v_and_b32 v8, 15, v1
    v_lshrrev_b32 v9, 4, v1
    v_accvgpr_read_b32 v14, a250
    v_accvgpr_read_b32 v252, a252
    v_accvgpr_read_b32 v253, a253
    v_accvgpr_read_b32 v254, a254
    v_accvgpr_read_b32 v255, a255
    s_waitcnt vmcnt(5)
    v_mfma_f32_16x16x32_bf16 v[16:19], v[156:159], a[0:3], 0
    buffer_load_dwordx4 v[180:183], v2, s[8:11], s60 offen offset:2048 sc1
    v_mfma_f32_16x16x32_bf16 v[20:23], v[156:159], a[4:7], 0
    v_mfma_f32_16x16x32_bf16 v[24:27], v[156:159], a[8:11], 0
    v_mfma_f32_16x16x32_bf16 v[28:31], v[156:159], a[12:15], 0
    v_mfma_f32_16x16x32_bf16 v[32:35], v[156:159], a[16:19], 0
    s_waitcnt vmcnt(5)
    v_mfma_f32_16x16x32_bf16 v[16:19], v[160:163], a[20:23], v[16:19]
    s_add_u32 s76, s92, 3
    v_mov_b32 v90, s76
    v_mov_b32 v91, 0
    s_mov_b64 exec, 1
    s_cmp_eq_u32 s12, 1
    s_cbranch_scc1 Lf_73
    buffer_store_dword v90, v91, s[8:11], s58 offen sc1
    s_branch Lg_74
Lf_73:
    buffer_store_dword v90, v91, s[8:11], s58 offen
Lg_74:
    s_mov_b64 exec, -1
    buffer_load_dwordx4 v[184:187], v2, s[8:11], s60 offen offset:3072 sc1
    v_mfma_f32_16x16x32_bf16 v[20:23], v[160:163], a[24:27], v[20:23]
    v_mfma_f32_16x16x32_bf16 v[24:27], v[160:163], a[28:31], v[24:27]
    v_mfma_f32_16x16x32_bf16 v[28:31], v[160:163], a[32:35], v[28:31]
    v_mfma_f32_16x16x32_bf16 v[32:35], v[160:163], a[36:39], v[32:35]
    s_waitcnt vmcnt(6)
    v_mfma_f32_16x16x32_bf16 v[16:19], v[164:167], a[40:43], v[16:19]
    s_add_u32 s60, s60, 4096
    buffer_load_dwordx4 v[188:191], v2, s[8:11], s60 offen offset:0 sc1
    v_mfma_f32_16x16x32_bf16 v[20:23], v[164:167], a[44:47], v[20:23]
    v_mfma_f32_16x16x32_bf16 v[24:27], v[164:167], a[48:51], v[24:27]
    v_mfma_f32_16x16x32_bf16 v[28:31], v[164:167], a[52:55], v[28:31]
    v_mfma_f32_16x16x32_bf16 v[32:35], v[164:167], a[56:59], v[32:35]
    s_waitcnt vmcnt(6)
    v_mfma_f32_16x16x32_bf16 v[16:19], v[168:171], a[60:63], v[16:19]
    buffer_load_dwordx4 v[96:99], v2, s[8:11], s60 offen offset:1024 sc1
    v_mfma_f32_16x16x32_bf16 v[20:23], v[168:171], a[64:67], v[20:23]
    v_mfma_f32_16x16x32_bf16 v[24:27], v[168:171], a[68:71], v[24:27]
    v_mfma_f32_16x16x32_bf16 v[28:31], v[168:171], a[72:75], v[28:31]
    v_mfma_f32_16x16x32_bf16 v[32:35], v[168:171], a[76:79], v[32:35]
    s_waitcnt vmcnt(6)
    v_mfma_f32_16x16x32_bf16 v[16:19], v[172:175], a[80:83], v[16:19]
    buffer_load_dwordx4 v[100:103], v2, s[8:11], s60 offen offset:2048 sc1
    v_mfma_f32_16x16x32_bf16 v[20:23], v[172:175], a[84:87], v[20:23]
    v_mfma_f32_16x16x32_bf16 v[24:27], v[172:175], a[88:91], v[24:27]
    v_mfma_f32_16x16x32_bf16 v[28:31], v[172:175], a[92:95], v[28:31]
    v_mfma_f32_16x16x32_bf16 v[32:35], v[172:175], a[96:99], v[32:35]
    s_waitcnt vmcnt(6)
    v_mfma_f32_16x16x32_bf16 v[16:19], v[176:179], a[100:103], v[16:19]
    buffer_load_dwordx4 v[104:107], v2, s[8:11], s60 offen offset:3072 sc1
    v_mfma_f32_16x16x32_bf16 v[20:23], v[176:179], a[104:107], v[20:23]
    v_mfma_f32_16x16x32_bf16 v[24:27], v[176:179], a[108:111], v[24:27]
    v_mfma_f32_16x16x32_bf16 v[28:31], v[176:179], a[112:115], v[28:31]
    v_mfma_f32_16x16x32_bf16 v[32:35], v[176:179], a[116:119], v[32:35]
    s_waitcnt vmcnt(6)
    v_mfma_f32_16x16x32_bf16 v[16:19], v[180:183], a[120:123], v[16:19]
    buffer_load_dwordx4 v[108:111], v2, s[8:11], s61 offen offset:0 sc1
    v_mfma_f32_16x16x32_bf16 v[20:23], v[180:183], a[124:127], v[20:23]
    v_mfma_f32_16x16x32_bf16 v[24:27], v[180:183], a[128:131], v[24:27]
    v_mfma_f32_16x16x32_bf16 v[28:31], v[180:183], a[132:135], v[28:31]
    v_mfma_f32_16x16x32_bf16 v[32:35], v[180:183], a[136:139], v[32:35]
    s_waitcnt vmcnt(5)
    v_mfma_f32_16x16x32_bf16 v[16:19], v[184:187], a[140:143], v[16:19]
    buffer_load_dwordx4 v[112:115], v2, s[8:11], s61 offen offset:1024 sc1
    v_mfma_f32_16x16x32_bf16 v[20:23], v[184:187], a[144:147], v[20:23]
    v_mfma_f32_16x16x32_bf16 v[24:27], v[184:187], a[148:151], v[24:27]
    v_mfma_f32_16x16x32_bf16 v[28:31], v[184:187], a[152:155], v[28:31]
    v_mfma_f32_16x16x32_bf16 v[32:35], v[184:187], a[156:159], v[32:35]
    s_waitcnt vmcnt(5)
    v_mfma_f32_16x16x32_bf16 v[16:19], v[188:191], a[160:163], v[16:19]
    buffer_load_dwordx4 v[116:119], v2, s[8:11], s61 offen offset:2048 sc1
    v_mfma_f32_16x16x32_bf16 v[20:23], v[188:191], a[164:167], v[20:23]
    v_mfma_f32_16x16x32_bf16 v[24:27], v[188:191], a[168:171], v[24:27]
    v_mfma_f32_16x16x32_bf16 v[28:31], v[188:191], a[172:175], v[28:31]
    v_mfma_f32_16x16x32_bf16 v[32:35], v[188:191], a[176:179], v[32:35]
    s_waitcnt vmcnt(5)
    v_mfma_f32_16x16x32_bf16 v[16:19], v[96:99], a[180:183], v[16:19]
    buffer_load_dwordx4 v[120:123], v2, s[8:11], s61 offen offset:3072 sc1
    v_mfma_f32_16x16x32_bf16 v[20:23], v[96:99], a[184:187], v[20:23]
    v_mfma_f32_16x16x32_bf16 v[24:27], v[96:99], a[188:191], v[24:27]
    v_mfma_f32_16x16x32_bf16 v[28:31], v[96:99], a[192:195], v[28:31]
    v_mfma_f32_16x16x32_bf16 v[32:35], v[96:99], a[196:199], v[32:35]
    s_waitcnt vmcnt(5)
    v_mfma_f32_16x16x32_bf16 v[16:19], v[100:103], a[200:203], v[16:19]
    s_add_u32 s61, s61, 4096
    buffer_load_dwordx4 v[124:127], v2, s[8:11], s61 offen offset:0 sc1
    v_mfma_f32_16x16x32_bf16 v[20:23], v[100:103], a[204:207], v[20:23]
    v_mfma_f32_16x16x32_bf16 v[24:27], v[100:103], a[208:211], v[24:27]
    v_mfma_f32_16x16x32_bf16 v[28:31], v[100:103], a[212:215], v[28:31]
    v_mfma_f32_16x16x32_bf16 v[32:35], v[100:103], a[216:219], v[32:35]
    s_waitcnt vmcnt(5)
    v_mfma_f32_16x16x32_bf16 v[16:19], v[104:107], a[220:223], v[16:19]
    buffer_load_dwordx4 v[128:131], v2, s[8:11], s61 offen offset:1024 sc1
    v_mfma_f32_16x16x32_bf16 v[20:23], v[104:107], a[224:227], v[20:23]
    v_mfma_f32_16x16x32_bf16 v[24:27], v[104:107], a[228:231], v[24:27]
    v_mfma_f32_16x16x32_bf16 v[28:31], v[104:107], a[232:235], v[28:31]
    v_mfma_f32_16x16x32_bf16 v[32:35], v[104:107], a[236:239], v[32:35]
    s_barrier
    s_waitcnt vmcnt(5)
    v_mfma_f32_16x16x32_bf16 v[36:39], v[108:111], a[0:3], 0
    buffer_load_dwordx4 v[132:135], v2, s[8:11], s61 offen offset:2048 sc1
    v_mfma_f32_16x16x32_bf16 v[40:43], v[108:111], a[4:7], 0
    ds_read_b64 v[232:233], v14 offset:20480
    v_mfma_f32_16x16x32_bf16 v[44:47], v[108:111], a[8:11], 0
    buffer_load_dword v13, v12, s[8:11], s57 offen sc1
    v_mfma_f32_16x16x32_bf16 v[48:51], v[108:111], a[12:15], 0
    ds_read_b64 v[234:235], v14 offset:22528
    v_mfma_f32_16x16x32_bf16 v[52:55], v[108:111], a[16:19], 0
    ds_read_b64 v[236:237], v14 offset:24576
    s_waitcnt vmcnt(6)
    v_mfma_f32_16x16x32_bf16 v[36:39], v[112:115], a[20:23], v[36:39]
    buffer_load_dwordx4 v[136:139], v2, s[8:11], s61 offen offset:3072 sc1
    v_mfma_f32_16x16x32_bf16 v[40:43], v[112:115], a[24:27], v[40:43]
    ds_read_b64 v[238:239], v14 offset:26624
    v_mfma_f32_16x16x32_bf16 v[44:47], v[112:115], a[28:31], v[44:47]
    ds_read_b64 v[240:241], v14 offset:28672
    v_mfma_f32_16x16x32_bf16 v[48:51], v[112:115], a[32:35], v[48:51]
    ds_write_b128 v4, v[16:19] offset:0
    v_mfma_f32_16x16x32_bf16 v[52:55], v[112:115], a[36:39], v[52:55]
    ds_read_b64 v[242:243], v14 offset:30720
    s_waitcnt vmcnt(6)
    v_mfma_f32_16x16x32_bf16 v[36:39], v[116:119], a[40:43], v[36:39]
    s_add_u32 s61, s61, 4096
    buffer_load_dwordx4 v[140:143], v2, s[8:11], s61 offen offset:0 sc1
    v_mfma_f32_16x16x32_bf16 v[40:43], v[116:119], a[44:47], v[40:43]
    v_mfma_f32_16x16x32_bf16 v[44:47], v[116:119], a[48:51], v[44:47]
    v_mfma_f32_16x16x32_bf16 v[48:51], v[116:119], a[52:55], v[48:51]
    ds_write_b128 v4, v[20:23] offset:1024
    v_mfma_f32_16x16x32_bf16 v[52:55], v[116:119], a[56:59], v[52:55]
    ds_read_b64 v[244:245], v14 offset:32768
    s_waitcnt vmcnt(6)
    v_mfma_f32_16x16x32_bf16 v[36:39], v[120:123], a[60:63], v[36:39]
    buffer_load_dwordx4 v[144:147], v2, s[8:11], s61 offen offset:1024 sc1
    v_mfma_f32_16x16x32_bf16 v[40:43], v[120:123], a[64:67], v[40:43]
    v_mfma_f32_16x16x32_bf16 v[44:47], v[120:123], a[68:71], v[44:47]
    v_mfma_f32_16x16x32_bf16 v[48:51], v[120:123], a[72:75], v[48:51]
    ds_write_b128 v4, v[24:27] offset:2048
    v_mfma_f32_16x16x32_bf16 v[52:55], v[120:123], a[76:79], v[52:55]
    ds_read_b64 v[246:247], v14 offset:34816
    s_waitcnt vmcnt(6)
    v_mfma_f32_16x16x32_bf16 v[36:39], v[124:127], a[80:83], v[36:39]
    buffer_load_dwordx4 v[148:151], v2, s[8:11], s61 offen offset:2048 sc1
    v_mfma_f32_16x16x32_bf16 v[40:43], v[124:127], a[84:87], v[40:43]
    v_mfma_f32_16x16x32_bf16 v[44:47], v[124:127], a[88:91], v[44:47]
    v_mfma_f32_16x16x32_bf16 v[48:51], v[124:127], a[92:95], v[48:51]
    ds_write_b128 v4, v[28:31] offset:3072
    v_mfma_f32_16x16x32_bf16 v[52:55], v[124:127], a[96:99], v[52:55]
    ds_read_b64 v[248:249], v14 offset:36864
    s_waitcnt vmcnt(6)
    v_mfma_f32_16x16x32_bf16 v[36:39], v[128:131], a[100:103], v[36:39]
    buffer_load_dwordx4 v[152:155], v2, s[8:11], s61 offen offset:3072 sc1
    v_mfma_f32_16x16x32_bf16 v[40:43], v[128:131], a[104:107], v[40:43]
    v_mfma_f32_16x16x32_bf16 v[44:47], v[128:131], a[108:111], v[44:47]
    v_mfma_f32_16x16x32_bf16 v[48:51], v[128:131], a[112:115], v[48:51]
    ds_write_b128 v4, v[32:35] offset:4096
    v_mfma_f32_16x16x32_bf16 v[52:55], v[128:131], a[116:119], v[52:55]
    ds_read_b64 v[250:251], v14 offset:38912
    s_waitcnt vmcnt(6)
    v_mfma_f32_16x16x32_bf16 v[36:39], v[132:135], a[120:123], v[36:39]
    s_waitcnt vmcnt(5)
    v_subrev_u32 v13, s92, v13
    v_add_u32 v13, -3, v13
    v_cmp_lt_u32 vcc, 7, v13
    s_cbranch_vccz L_hok2
    s_mov_b32 s79, 0
Lpoll_75:
    buffer_load_dword v13, v12, s[8:11], s57 offen sc1
    s_waitcnt vmcnt(0)
    v_subrev_u32 v13, s92, v13
    v_add_u32 v13, -3, v13
    v_cmp_lt_u32 vcc, 7, v13
    s_cbranch_vccz Lpd_76
    s_add_u32 s79, s79, 1
    s_cmp_lt_u32 s79, s80
    s_cbranch_scc1 Lpoll_75
    s_mov_b32 s80, 0
Lpd_76:
L_hok2:
    buffer_load_dwordx4 v[156:159], v2, s[8:11], s62 offen offset:0 sc1
    v_mfma_f32_16x16x32_bf16 v[40:43], v[132:135], a[124:127], v[40:43]
    v_mfma_f32_16x16x32_bf16 v[44:47], v[132:135], a[128:131], v[44:47]
    v_mfma_f32_16x16x32_bf16 v[48:51], v[132:135], a[132:135], v[48:51]
    v_mfma_f32_16x16x32_bf16 v[52:55], v[132:135], a[136:139], v[52:55]
    s_waitcnt vmcnt(5)
    v_mfma_f32_16x16x32_bf16 v[36:39], v[136:139], a[140:143], v[36:39]
    buffer_load_dwordx4 v[160:163], v2, s[8:11], s62 offen offset:1024 sc1
    v_mfma_f32_16x16x32_bf16 v[40:43], v[136:139], a[144:147], v[40:43]
    v_mfma_f32_16x16x32_bf16 v[44:47], v[136:139], a[148:151], v[44:47]
    v_mfma_f32_16x16x32_bf16 v[48:51], v[136:139], a[152:155], v[48:51]
    v_mfma_f32_16x16x32_bf16 v[52:55], v[136:139], a[156:159], v[52:55]
    s_waitcnt vmcnt(5)
    v_mfma_f32_16x16x32_bf16 v[36:39], v[140:143], a[160:163], v[36:39]
    buffer_load_dwordx4 v[164:167], v2, s[8:11], s62 offen offset:2048 sc1
    v_mfma_f32_16x16x32_bf16 v[40:43], v[140:143], a[164:167], v[40:43]
    v_mfma_f32_16x16x32_bf16 v[44:47], v[140:143], a[168:171], v[44:47]
    v_mfma_f32_16x16x32_bf16 v[48:51], v[140:143], a[172:175], v[48:51]
    v_mfma_f32_16x16x32_bf16 v[52:55], v[140:143], a[176:179], v[52:55]
    s_waitcnt vmcnt(5)
    v_mfma_f32_16x16x32_bf16 v[36:39], v[144:147], a[180:183], v[36:39]
    buffer_load_dwordx4 v[168:171], v2, s[8:11], s62 offen offset:3072 sc1
    v_mfma_f32_16x16x32_bf16 v[40:43], v[144:147], a[184:187], v[40:43]
    v_mfma_f32_16x16x32_bf16 v[44:47], v[144:147], a[188:191], v[44:47]
    v_mfma_f32_16x16x32_bf16 v[48:51], v[144:147], a[192:195], v[48:51]
    v_mfma_f32_16x16x32_bf16 v[52:55], v[144:147], a[196:199], v[52:55]
    s_waitcnt vmcnt(5)
    v_mfma_f32_16x16x32_bf16 v[36:39], v[148:151], a[200:203], v[36:39]
    s_add_u32 s62, s62, 4096
    buffer_load_dwordx4 v[172:175], v2, s[8:11], s62 offen offset:0 sc1
    v_mfma_f32_16x16x32_bf16 v[40:43], v[148:151], a[204:207], v[40:43]
    v_mfma_f32_16x16x32_bf16 v[44:47], v[148:151], a[208:211], v[44:47]
    v_mfma_f32_16x16x32_bf16 v[48:51], v[148:151], a[212:215], v[48:51]
    v_mfma_f32_16x16x32_bf16 v[52:55], v[148:151], a[216:219], v[52:55]
    s_waitcnt vmcnt(5)
    v_mfma_f32_16x16x32_bf16 v[36:39], v[152:155], a[220:223], v[36:39]
    buffer_load_dwordx4 v[176:179], v2, s[8:11], s62 offen offset:1024 sc1
    v_mfma_f32_16x16x32_bf16 v[40:43], v[152:155], a[224:227], v[40:43]
    v_mfma_f32_16x16x32_bf16 v[44:47], v[152:155], a[228:231], v[44:47]
    v_mfma_f32_16x16x32_bf16 v[48:51], v[152:155], a[232:235], v[48:51]
    v_mfma_f32_16x16x32_bf16 v[52:55], v[152:155], a[236:239], v[52:55]
    s_waitcnt lgkmcnt(0)
    s_barrier
    s_waitcnt vmcnt(5)
    v_mfma_f32_16x16x32_bf16 v[56:59], v[156:159], a[0:3], 0
    buffer_load_dwordx4 v[180:183], v2, s[8:11], s62 offen offset:2048 sc1
    v_mfma_f32_16x16x32_bf16 v[60:63], v[156:159], a[4:7], 0
    ds_read_b128 v[192:195], v7 offset:0
    v_mfma_f32_16x16x32_bf16 v[64:67], v[156:159], a[8:11], 0
    ds_read_b128 v[196:199], v7 offset:1024
    v_mfma_f32_16x16x32_bf16 v[68:71], v[156:159], a[12:15], 0
    ds_read_b128 v[200:203], v7 offset:2048
    v_mfma_f32_16x16x32_bf16 v[72:75], v[156:159], a[16:19], 0
    ds_read_b128 v[204:207], v7 offset:3072
    s_waitcnt vmcnt(5)
    v_mfma_f32_16x16x32_bf16 v[56:59], v[160:163], a[20:23], v[56:59]
    buffer_load_dwordx4 v[184:187], v2, s[8:11], s62 offen offset:3072 sc1
    v_mfma_f32_16x16x32_bf16 v[60:63], v[160:163], a[24:27], v[60:63]
    ds_read_b128 v[208:211], v7 offset:4096
    v_mfma_f32_16x16x32_bf16 v[64:67], v[160:163], a[28:31], v[64:67]
    ds_write_b128 v5, v[36:39] offset:0
    v_mfma_f32_16x16x32_bf16 v[68:71], v[160:163], a[32:35], v[68:71]
    v_lshlrev_b32 v10, 16, v232
    v_and_b32 v11, s21, v232
    v_mfma_f32_16x16x32_bf16 v[72:75], v[160:163], a[36:39], v[72:75]
    s_waitcnt lgkmcnt(1)
    v_add_f32 v192, v192, v10
    v_add_f32 v193, v193, v11
    s_waitcnt vmcnt(5)
    v_mfma_f32_16x16x32_bf16 v[56:59], v[164:167], a[40:43], v[56:59]
    s_add_u32 s62, s62, 4096
    buffer_load_dwordx4 v[188:191], v2, s[8:11], s62 offen offset:0 sc1
    v_mfma_f32_16x16x32_bf16 v[60:63], v[164:167], a[44:47], v[60:63]
    v_lshlrev_b32 v10, 16, v233
    v_and_b32 v11, s21, v233
    v_mfma_f32_16x16x32_bf16 v[64:67], v[164:167], a[48:51], v[64:67]
    v_add_f32 v194, v194, v10
    v_add_f32 v195, v195, v11
    v_mfma_f32_16x16x32_bf16 v[68:71], v[164:167], a[52:55], v[68:71]
    ds_write_b128 v5, v[40:43] offset:1024
    v_mfma_f32_16x16x32_bf16 v[72:75], v[164:167], a[56:59], v[72:75]
    v_lshlrev_b32 v10, 16, v234
    v_and_b32 v11, s21, v234
    s_waitcnt vmcnt(5)
    v_mfma_f32_16x16x32_bf16 v[56:59], v[168:171], a[60:63], v[56:59]
    buffer_load_dwordx4 v[96:99], v2, s[8:11], s62 offen offset:1024 sc1
    v_mfma_f32_16x16x32_bf16 v[60:63], v[168:171], a[64:67], v[60:63]
    v_add_f32 v196, v196, v10
    v_add_f32 v197, v197, v11
    v_mfma_f32_16x16x32_bf16 v[64:67], v[168:171], a[68:71], v[64:67]
    v_lshlrev_b32 v10, 16, v235
    v_and_b32 v11, s21, v235
    v_mfma_f32_16x16x32_bf16 v[68:71], v[168:171], a[72:75], v[68:71]
    v_add_f32 v198, v198, v10
    v_add_f32 v199, v199, v11
    v_mfma_f32_16x16x32_bf16 v[72:75], v[168:171], a[76:79], v[72:75]
    ds_write_b128 v5, v[44:47] offset:2048
    s_waitcnt vmcnt(5)
    v_mfma_f32_16x16x32_bf16 v[56:59], v[172:175], a[80:83], v[56:59]
    buffer_load_dwordx4 v[100:103], v2, s[8:11], s62 offen offset:2048 sc1
    v_mfma_f32_16x16x32_bf16 v[60:63], v[172:175], a[84:87], v[60:63]
    v_lshlrev_b32 v10, 16, v236
    v_and_b32 v11, s21, v236
    v_mfma_f32_16x16x32_bf16 v[64:67], v[172:175], a[88:91], v[64:67]
    v_add_f32 v200, v200, v10
    v_add_f32 v201, v201, v11
    v_mfma_f32_16x16x32_bf16 v[68:71], v[172:175], a[92:95], v[68:71]
    v_lshlrev_b32 v10, 16, v237
    v_and_b32 v11, s21, v237
    v_mfma_f32_16x16x32_bf16 v[72:75], v[172:175], a[96:99], v[72:75]
    v_add_f32 v202, v202, v10
    v_add_f32 v203, v203, v11
    s_waitcnt vmcnt(5)
    v_mfma_f32_16x16x32_bf16 v[56:59], v[176:179], a[100:103], v[56:59]
    buffer_load_dwordx4 v[104:107], v2, s[8:11], s62 offen offset:3072 sc1
    v_mfma_f32_16x16x32_bf16 v[60:63], v[176:179], a[104:107], v[60:63]
    ds_write_b128 v5, v[48:51] offset:3072
    v_mfma_f32_16x16x32_bf16 v[64:67], v[176:179], a[108:111], v[64:67]
    v_lshlrev_b32 v10, 16, v238
    v_and_b32 v11, s21, v238
    v_mfma_f32_16x16x32_bf16 v[68:71], v[176:179], a[112:115], v[68:71]
    v_add_f32 v204, v204, v10
    v_add_f32 v205, v205, v11
    v_mfma_f32_16x16x32_bf16 v[72:75], v[176:179], a[116:119], v[72:75]
    v_lshlrev_b32 v10, 16, v239
    v_and_b32 v11, s21, v239
    s_waitcnt vmcnt(5)
    v_mfma_f32_16x16x32_bf16 v[56:59], v[180:183], a[120:123], v[56:59]
    buffer_load_dwordx4 v[108:111], v2, s[8:11], s63 offen offset:0 sc1
    v_mfma_f32_16x16x32_bf16 v[60:63], v[180:183], a[124:127], v[60:63]
    v_add_f32 v206, v206, v10
    v_add_f32 v207, v207, v11
    v_mfma_f32_16x16x32_bf16 v[64:67], v[180:183], a[128:131], v[64:67]
    ds_write_b128 v5, v[52:55] offset:4096
    v_mfma_f32_16x16x32_bf16 v[68:71], v[180:183], a[132:135], v[68:71]
    v_lshlrev_b32 v10, 16, v240
    v_and_b32 v11, s21, v240
    v_mfma_f32_16x16x32_bf16 v[72:75], v[180:183], a[136:139], v[72:75]
    v_add_f32 v208, v208, v10
    v_add_f32 v209, v209, v11
    s_waitcnt vmcnt(5)
    v_mfma_f32_16x16x32_bf16 v[56:59], v[184:187], a[140:143], v[56:59]
    buffer_load_dwordx4 v[112:115], v2, s[8:11], s63 offen offset:1024 sc1
    v_mfma_f32_16x16x32_bf16 v[60:63], v[184:187], a[144:147], v[60:63]
    v_lshlrev_b32 v10, 16, v241
    v_and_b32 v11, s21, v241
    v_mfma_f32_16x16x32_bf16 v[64:67], v[184:187], a[148:151], v[64:67]
    v_add_f32 v210, v210, v10
    v_add_f32 v211, v211, v11
    v_mfma_f32_16x16x32_bf16 v[68:71], v[184:187], a[152:155], v[68:71]
    v_mfma_f32_16x16x32_bf16 v[72:75], v[184:187], a[156:159], v[72:75]
    s_waitcnt vmcnt(5)
    v_mfma_f32_16x16x32_bf16 v[56:59], v[188:191], a[160:163], v[56:59]
    buffer_load_dwordx4 v[116:119], v2, s[8:11], s63 offen offset:2048 sc1
    v_mfma_f32_16x16x32_bf16 v[60:63], v[188:191], a[164:167], v[60:63]
    v_mfma_f32_16x16x32_bf16 v[64:67], v[188:191], a[168:171], v[64:67]
    v_mfma_f32_16x16x32_bf16 v[68:71], v[188:191], a[172:175], v[68:71]
    v_mfma_f32_16x16x32_bf16 v[72:75], v[188:191], a[176:179], v[72:75]
    s_waitcnt vmcnt(5)
    v_mfma_f32_16x16x32_bf16 v[56:59], v[96:99], a[180:183], v[56:59]
    buffer_load_dwordx4 v[120:123], v2, s[8:11], s63 offen offset:3072 sc1
    v_mfma_f32_16x16x32_bf16 v[60:63], v[96:99], a[184:187], v[60:63]
    v_mfma_f32_16x16x32_bf16 v[64:67], v[96:99], a[188:191], v[64:67]
    v_mfma_f32_16x16x32_bf16 v[68:71], v[96:99], a[192:195], v[68:71]
    v_mfma_f32_16x16x32_bf16 v[72:75], v[96:99], a[196:199], v[72:75]
    s_waitcnt vmcnt(5)
    v_mfma_f32_16x16x32_bf16 v[56:59], v[100:103], a[200:203], v[56:59]
    s_add_u32 s63, s63, 4096
    buffer_load_dwordx4 v[124:127], v2, s[8:11], s63 offen offset:0 sc1
    v_mfma_f32_16x16x32_bf16 v[60:63], v[100:103], a[204:207], v[60:63]
    v_mfma_f32_16x16x32_bf16 v[64:67], v[100:103], a[208:211], v[64:67]
    v_mfma_f32_16x16x32_bf16 v[68:71], v[100:103], a[212:215], v[68:71]
    v_mfma_f32_16x16x32_bf16 v[72:75], v[100:103], a[216:219], v[72:75]
    s_waitcnt vmcnt(5)
    v_mfma_f32_16x16x32_bf16 v[56:59], v[104:107], a[220:223], v[56:59]
    buffer_load_dwordx4 v[128:131], v2, s[8:11], s63 offen offset:1024 sc1
    v_mfma_f32_16x16x32_bf16 v[60:63], v[104:107], a[224:227], v[60:63]
    v_mfma_f32_16x16x32_bf16 v[64:67], v[104:107], a[228:231], v[64:67]
    v_mfma_f32_16x16x32_bf16 v[68:71], v[104:107], a[232:235], v[68:71]
    v_mfma_f32_16x16x32_bf16 v[72:75], v[104:107], a[236:239], v[72:75]
    s_waitcnt lgkmcnt(0)
    s_barrier
    s_waitcnt vmcnt(5)
    v_mfma_f32_16x16x32_bf16 v[76:79], v[108:111], a[0:3], v[192:195]
    buffer_load_dwordx4 v[132:135], v2, s[8:11], s63 offen offset:2048 sc1
    v_mfma_f32_16x16x32_bf16 v[80:83], v[108:111], a[4:7], v[196:199]
    ds_read_b128 v[212:215], v7 offset:20480
    v_mfma_f32_16x16x32_bf16 v[84:87], v[108:111], a[8:11], v[200:203]
    ds_read_b128 v[216:219], v7 offset:21504
    v_mfma_f32_16x16x32_bf16 v[88:91], v[108:111], a[12:15], v[204:207]
    ds_read_b128 v[220:223], v7 offset:22528
    v_mfma_f32_16x16x32_bf16 v[92:95], v[108:111], a[16:19], v[208:211]
    ds_read_b128 v[224:227], v7 offset:23552
    s_waitcnt vmcnt(5)
    v_mfma_f32_16x16x32_bf16 v[76:79], v[112:115], a[20:23], v[76:79]
    buffer_load_dwordx4 v[136:139], v2, s[8:11], s63 offen offset:3072 sc1
    v_mfma_f32_16x16x32_bf16 v[80:83], v[112:115], a[24:27], v[80:83]
    ds_read_b128 v[228:231], v7 offset:24576
    v_mfma_f32_16x16x32_bf16 v[84:87], v[112:115], a[28:31], v[84:87]
    ds_write_b128 v6, v[56:59] offset:0
    v_mfma_f32_16x16x32_bf16 v[88:91], v[112:115], a[32:35], v[88:91]
    v_lshlrev_b32 v176, 16, v242
    v_and_b32 v177, s21, v242
    v_mfma_f32_16x16x32_bf16 v[92:95], v[112:115], a[36:39], v[92:95]
    v_lshlrev_b32 v178, 16, v243
    v_and_b32 v179, s21, v243
    s_waitcnt vmcnt(5)
    v_mfma_f32_16x16x32_bf16 v[76:79], v[116:119], a[40:43], v[76:79]
    s_add_u32 s63, s63, 4096
    buffer_load_dwordx4 v[140:143], v2, s[8:11], s63 offen offset:0 sc1
    v_mfma_f32_16x16x32_bf16 v[80:83], v[116:119], a[44:47], v[80:83]
    ds_write_b128 v6, v[60:63] offset:1024
    v_mfma_f32_16x16x32_bf16 v[84:87], v[116:119], a[48:51], v[84:87]
    v_lshlrev_b32 v180, 16, v244
    v_and_b32 v181, s21, v244
    v_mfma_f32_16x16x32_bf16 v[88:91], v[116:119], a[52:55], v[88:91]
    v_lshlrev_b32 v182, 16, v245
    v_and_b32 v183, s21, v245
    v_mfma_f32_16x16x32_bf16 v[92:95], v[116:119], a[56:59], v[92:95]
    ds_write_b128 v6, v[64:67] offset:2048
    s_waitcnt vmcnt(5)
    v_mfma_f32_16x16x32_bf16 v[76:79], v[120:123], a[60:63], v[76:79]
    buffer_load_dwordx4 v[144:147], v2, s[8:11], s63 offen offset:1024 sc1
    v_mfma_f32_16x16x32_bf16 v[80:83], v[120:123], a[64:67], v[80:83]
    v_lshlrev_b32 v184, 16, v246
    v_and_b32 v185, s21, v246
    v_mfma_f32_16x16x32_bf16 v[84:87], v[120:123], a[68:71], v[84:87]
    v_lshlrev_b32 v186, 16, v247
    v_and_b32 v187, s21, v247
    v_mfma_f32_16x16x32_bf16 v[88:91], v[120:123], a[72:75], v[88:91]
    ds_write_b128 v6, v[68:71] offset:3072
    v_mfma_f32_16x16x32_bf16 v[92:95], v[120:123], a[76:79], v[92:95]
    v_lshlrev_b32 v188, 16, v248
    v_and_b32 v189, s21, v248
    s_waitcnt vmcnt(5)
    v_mfma_f32_16x16x32_bf16 v[76:79], v[124:127], a[80:83], v[76:79]
    buffer_load_dwordx4 v[148:151], v2, s[8:11], s63 offen offset:2048 sc1
    v_mfma_f32_16x16x32_bf16 v[80:83], v[124:127], a[84:87], v[80:83]
    v_lshlrev_b32 v190, 16, v249
    v_and_b32 v191, s21, v249
    v_mfma_f32_16x16x32_bf16 v[84:87], v[124:127], a[88:91], v[84:87]
    ds_write_b128 v6, v[72:75] offset:4096
    v_mfma_f32_16x16x32_bf16 v[88:91], v[124:127], a[92:95], v[88:91]
    v_lshlrev_b32 v192, 16, v250
    v_and_b32 v193, s21, v250
    v_mfma_f32_16x16x32_bf16 v[92:95], v[124:127], a[96:99], v[92:95]
    v_lshlrev_b32 v194, 16, v251
    v_and_b32 v195, s21, v251
    s_waitcnt vmcnt(5)
    v_mfma_f32_16x16x32_bf16 v[76:79], v[128:131], a[100:103], v[76:79]
    buffer_load_dwordx4 v[152:155], v2, s[8:11], s63 offen offset:3072 sc1
    v_mfma_f32_16x16x32_bf16 v[80:83], v[128:131], a[104:107], v[80:83]
    v_add_u32 v100, 0, v1
    v_mul_u32_u24 v96, 6554, v100
    v_mfma_f32_16x16x32_bf16 v[84:87], v[128:131], a[108:111], v[84:87]
    v_lshrrev_b32 v96, 16, v96
    v_mul_u32_u24 v99, 10, v96
    v_mfma_f32_16x16x32_bf16 v[88:91], v[128:131], a[112:115], v[88:91]
    v_sub_u32 v100, v100, v99
    v_lshlrev_b32 v100, 4, v100
    v_mfma_f32_16x16x32_bf16 v[92:95], v[128:131], a[116:119], v[92:95]
    v_add_u32 v101, 64, v1
    v_mul_u32_u24 v97, 6554, v101
    s_waitcnt vmcnt(5)
    v_mfma_f32_16x16x32_bf16 v[76:79], v[132:135], a[120:123], v[76:79]
    s_waitcnt lgkmcnt(0)
    s_barrier
    v_mfma_f32_16x16x32_bf16 v[80:83], v[132:135], a[124:127], v[80:83]
    ds_read_b128 v[156:159], v7 offset:0
    v_mfma_f32_16x16x32_bf16 v[84:87], v[132:135], a[128:131], v[84:87]
    ds_read_b128 v[160:163], v7 offset:1024
    v_mfma_f32_16x16x32_bf16 v[88:91], v[132:135], a[132:135], v[88:91]
    ds_read_b128 v[164:167], v7 offset:2048
    v_mfma_f32_16x16x32_bf16 v[92:95], v[132:135], a[136:139], v[92:95]
    ds_read_b128 v[168:171], v7 offset:3072
    s_waitcnt vmcnt(4)
    v_mfma_f32_16x16x32_bf16 v[76:79], v[136:139], a[140:143], v[76:79]
    ds_read_b128 v[172:175], v7 offset:4096
    v_mfma_f32_16x16x32_bf16 v[80:83], v[136:139], a[144:147], v[80:83]
    v_lshrrev_b32 v97, 16, v97
    v_mul_u32_u24 v99, 10, v97
    v_mfma_f32_16x16x32_bf16 v[84:87], v[136:139], a[148:151], v[84:87]
    v_sub_u32 v101, v101, v99
    v_lshlrev_b32 v101, 4, v101
    v_mfma_f32_16x16x32_bf16 v[88:91], v[136:139], a[152:155], v[88:91]
    v_add_u32 v102, 128, v1
    v_mul_u32_u24 v98, 6554, v102
    v_mfma_f32_16x16x32_bf16 v[92:95], v[136:139], a[156:159], v[92:95]
    s_waitcnt lgkmcnt(0)
    v_add_f32 v212, v212, v156
    v_add_f32 v213, v213, v157
    s_waitcnt vmcnt(3)
    v_mfma_f32_16x16x32_bf16 v[76:79], v[140:143], a[160:163], v[76:79]
    v_add_f32 v214, v214, v158
    v_add_f32 v215, v215, v159
    v_mfma_f32_16x16x32_bf16 v[80:83], v[140:143], a[164:167], v[80:83]
    v_add_f32 v216, v216, v160
    v_add_f32 v217, v217, v161
    v_mfma_f32_16x16x32_bf16 v[84:87], v[140:143], a[168:171], v[84:87]
    v_add_f32 v218, v218, v162
    v_add_f32 v219, v219, v163
    v_mfma_f32_16x16x32_bf16 v[88:91], v[140:143], a[172:175], v[88:91]
    v_add_f32 v220, v220, v164
    v_add_f32 v221, v221, v165
    v_mfma_f32_16x16x32_bf16 v[92:95], v[140:143], a[176:179], v[92:95]
    v_add_f32 v222, v222, v166
    v_add_f32 v223, v223, v167
    s_waitcnt vmcnt(2)
    v_mfma_f32_16x16x32_bf16 v[76:79], v[144:147], a[180:183], v[76:79]
    v_add_f32 v224, v224, v168
    v_add_f32 v225, v225, v169
    v_mfma_f32_16x16x32_bf16 v[80:83], v[144:147], a[184:187], v[80:83]
    v_add_f32 v226, v226, v170
    v_add_f32 v227, v227, v171
    v_mfma_f32_16x16x32_bf16 v[84:87], v[144:147], a[188:191], v[84:87]
    v_add_f32 v228, v228, v172
    v_add_f32 v229, v229, v173
    v_mfma_f32_16x16x32_bf16 v[88:91], v[144:147], a[192:195], v[88:91]
    v_add_f32 v230, v230, v174
    v_add_f32 v231, v231, v175
    v_mfma_f32_16x16x32_bf16 v[92:95], v[144:147], a[196:199], v[92:95]
    v_lshrrev_b32 v98, 16, v98
    v_mul_u32_u24 v99, 10, v98
    s_waitcnt vmcnt(1)
    v_mfma_f32_16x16x32_bf16 v[76:79], v[148:151], a[200:203], v[76:79]
    v_sub_u32 v102, v102, v99
    v_lshlrev_b32 v102, 4, v102
    v_mfma_f32_16x16x32_bf16 v[80:83], v[148:151], a[204:207], v[80:83]
    v_mfma_f32_16x16x32_bf16 v[84:87], v[148:151], a[208:211], v[84:87]
    v_mfma_f32_16x16x32_bf16 v[88:91], v[148:151], a[212:215], v[88:91]
    v_mfma_f32_16x16x32_bf16 v[92:95], v[148:151], a[216:219], v[92:95]
    s_waitcnt vmcnt(0)
    v_mfma_f32_16x16x32_bf16 v[76:79], v[152:155], a[220:223], v[76:79]
    v_mfma_f32_16x16x32_bf16 v[80:83], v[152:155], a[224:227], v[80:83]
    v_mfma_f32_16x16x32_bf16 v[84:87], v[152:155], a[228:231], v[84:87]
    v_mfma_f32_16x16x32_bf16 v[88:91], v[152:155], a[232:235], v[88:91]
    v_mfma_f32_16x16x32_bf16 v[92:95], v[152:155], a[236:239], v[92:95]
    s_nop 3
    v_pk_add_f32 v[76:77], v[76:77], v[212:213]
    v_pk_add_f32 v[78:79], v[78:79], v[214:215]
    v_pk_add_f32 v[80:81], v[80:81], v[216:217]
    v_pk_add_f32 v[82:83], v[82:83], v[218:219]
    v_pk_add_f32 v[84:85], v[84:85], v[220:221]
    v_pk_add_f32 v[86:87], v[86:87], v[222:223]
    v_pk_add_f32 v[88:89], v[88:89], v[224:225]
    v_pk_add_f32 v[90:91], v[90:91], v[226:227]
    v_pk_add_f32 v[92:93], v[92:93], v[228:229]
    v_pk_add_f32 v[94:95], v[94:95], v[230:231]
    s_cmp_eq_u32 s13, 1
    s_cbranch_scc1 L_out
    v_pk_add_f32 v[16:17], v[76:77], v[80:81]
    v_pk_mul_f32 v[20:21], v[76:77], v[76:77]
    v_pk_add_f32 v[18:19], v[78:79], v[82:83]
    v_pk_mul_f32 v[22:23], v[78:79], v[78:79]
    v_pk_fma_f32 v[20:21], v[80:81], v[80:81], v[20:21]
    v_pk_fma_f32 v[22:23], v[82:83], v[82:83], v[22:23]
    v_pk_add_f32 v[16:17], v[16:17], v[84:85]
    v_pk_fma_f32 v[20:21], v[84:85], v[84:85], v[20:21]
    v_pk_add_f32 v[18:19], v[18:19], v[86:87]
    v_pk_fma_f32 v[22:23], v[86:87], v[86:87], v[22:23]
    v_pk_add_f32 v[16:17], v[16:17], v[88:89]
    v_pk_fma_f32 v[20:21], v[88:89], v[88:89], v[20:21]
    v_pk_add_f32 v[18:19], v[18:19], v[90:91]
    v_pk_fma_f32 v[22:23], v[90:91], v[90:91], v[22:23]
    v_pk_add_f32 v[16:17], v[16:17], v[92:93]
    v_pk_fma_f32 v[20:21], v[92:93], v[92:93], v[20:21]
    v_pk_add_f32 v[18:19], v[18:19], v[94:95]
    v_pk_fma_f32 v[22:23], v[94:95], v[94:95], v[22:23]
    v_add_f32_dpp v16, v16, v16 row_ror:8 row_mask:0xf bank_mask:0x3
    v_add_f32_dpp v17, v17, v17 row_ror:8 row_mask:0xf bank_mask:0x3
    v_add_f32_dpp v18, v18, v18 row_ror:8 row_mask:0xf bank_mask:0x3
    v_add_f32_dpp v19, v19, v19 row_ror:8 row_mask:0xf bank_mask:0x3
    v_add_f32_dpp v16, v20, v20 row_ror:8 row_mask:0xf bank_mask:0xc
    v_add_f32_dpp v17, v21, v21 row_ror:8 row_mask:0xf bank_mask:0xc
    v_add_f32_dpp v18, v22, v22 row_ror:8 row_mask:0xf bank_mask:0xc
    v_add_f32_dpp v19, v23, v23 row_ror:8 row_mask:0xf bank_mask:0xc
    v_add_f32_dpp v16, v16, v16 row_half_mirror row_mask:0xf bank_mask:0x5
    v_add_f32_dpp v17, v17, v17 row_half_mirror row_mask:0xf bank_mask:0x5
    s_nop 0
    v_add_f32_dpp v16, v18, v18 row_half_mirror row_mask:0xf bank_mask:0xa
    v_add_f32_dpp v17, v19, v19 row_half_mirror row_mask:0xf bank_mask:0xa
    s_nop 0
    v_add_f32_dpp v16, v16, v16 quad_perm:[1,0,3,2] row_mask:0xf bank_mask:0xf
    v_add_f32_dpp v17, v17, v17 quad_perm:[1,0,3,2] row_mask:0xf bank_mask:0xf
    s_nop 0
    v_add_f32_dpp v16, v16, v16 quad_perm:[2,3,0,1] row_mask:0xf bank_mask:0xf
    v_add_f32_dpp v17, v17, v17 quad_perm:[2,3,0,1] row_mask:0xf bank_mask:0xf
    s_mov_b32 s23, 0x11111111
    s_mov_b32 exec_lo, s23
    s_mov_b32 exec_hi, s23
    s_cmp_eq_u32 s12, 1
    s_cbranch_scc1 Lf_77
    buffer_store_dwordx2 v[16:17], v252, s[8:11], s22 offen sc1
    s_branch Lg_78
Lf_77:
    buffer_store_dwordx2 v[16:17], v252, s[8:11], s22 offen
Lg_78:
    s_mov_b64 exec, -1
    s_mov_b32 s79, 0
Lpoll_79:
    buffer_load_dwordx4 v[24:27], v253, s[8:11], s20 offen sc1
    s_waitcnt vmcnt(0)
    v_max_u32 v12, v24, v25
    v_max3_u32 v12, v12, v26, v27
    v_cmp_eq_u32 vcc, -1, v12
    s_cbranch_vccz Lpd_80
    s_add_u32 s79, s79, 1
    s_cmp_lt_u32 s79, s80
    s_cbranch_scc1 Lpoll_79
    s_mov_b32 s80, 0
Lpd_80:
    v_add_f32_dpp v24, v24, v24 quad_perm:[1,0,3,2] row_mask:0xf bank_mask:0xf
    v_add_f32_dpp v25, v25, v25 quad_perm:[1,0,3,2] row_mask:0xf bank_mask:0xf
    v_add_f32_dpp v26, v26, v26 quad_perm:[1,0,3,2] row_mask:0xf bank_mask:0xf
    v_add_f32_dpp v27, v27, v27 quad_perm:[1,0,3,2] row_mask:0xf bank_mask:0xf
    v_add_f32_dpp v24, v24, v24 quad_perm:[2,3,0,1] row_mask:0xf bank_mask:0xf
    v_add_f32_dpp v25, v25, v25 quad_perm:[2,3,0,1] row_mask:0xf bank_mask:0xf
    v_add_f32_dpp v26, v26, v26 quad_perm:[2,3,0,1] row_mask:0xf bank_mask:0xf
    v_add_f32_dpp v27, v27, v27 quad_perm:[2,3,0,1] row_mask:0xf bank_mask:0xf
    v_add_f32_dpp v24, v24, v24 row_half_mirror row_mask:0xf bank_mask:0xf
    v_add_f32_dpp v25, v25, v25 row_half_mirror row_mask:0xf bank_mask:0xf
    v_add_f32_dpp v26, v26, v26 row_half_mirror row_mask:0xf bank_mask:0xf
    v_add_f32_dpp v27, v27, v27 row_half_mirror row_mask:0xf bank_mask:0xf
    s_mov_b32 vcc_lo, 0x00ff00ff
    s_mov_b32 vcc_hi, 0x00ff00ff
    v_mov_b32_dpp v28, v24 row_ror:8 row_mask:0xf bank_mask:0xf
    v_mov_b32_dpp v29, v25 row_ror:8 row_mask:0xf bank_mask:0xf
    v_mov_b32_dpp v30, v26 row_ror:8 row_mask:0xf bank_mask:0xf
    v_mov_b32_dpp v31, v27 row_ror:8 row_mask:0xf bank_mask:0xf
    v_cndmask_b32 v16, v28, v24, vcc
    v_cndmask_b32 v17, v29, v25, vcc
    v_cndmask_b32 v18, v30, v26, vcc
    v_cndmask_b32 v19, v31, v27, vcc
    v_cndmask_b32 v20, v24, v28, vcc
    v_cndmask_b32 v21, v25, v29, vcc
    v_cndmask_b32 v22, v26, v30, vcc
    v_cndmask_b32 v23, v27, v31, vcc
    s_mov_b32 s24, 0x3acccccd
    s_mov_b32 s25, s24
    v_pk_mul_f32 v[16:17], v[16:17], s[24:25]
    v_pk_mul_f32 v[18:19], v[18:19], s[24:25]
    v_pk_mul_f32 v[20:21], v[20:21], s[24:25]
    v_pk_mul_f32 v[22:23], v[22:23], s[24:25]
    v_fma_f32 v20, -v16, v16, v20
    v_fma_f32 v21, -v17, v17, v21
    v_fma_f32 v22, -v18, v18, v22
    v_fma_f32 v23, -v19, v19, v23
    v_max_f32 v20, 0, v20
    v_max_f32 v21, 0, v21
    v_max_f32 v22, 0, v22
    v_max_f32 v23, 0, v23
    v_add_f32 v20, 0x3727c5ac, v20
    v_add_f32 v21, 0x3727c5ac, v21
    v_add_f32 v22, 0x3727c5ac, v22
    v_add_f32 v23, 0x3727c5ac, v23
    v_rsq_f32 v20, v20
    v_rsq_f32 v21, v21
    v_rsq_f32 v22, v22
    v_rsq_f32 v23, v23
    v_mul_f32_e64 v16, -v16, v20
    v_mul_f32_e64 v17, -v17, v21
    v_mul_f32_e64 v18, -v18, v22
    v_mul_f32_e64 v19, -v19, v23
    v_pk_fma_f32 v[52:53], v[76:77], v[20:21], v[16:17]
    v_pk_fma_f32 v[54:55], v[78:79], v[22:23], v[18:19]
    v_pk_fma_f32 v[56:57], v[80:81], v[20:21], v[16:17]
    v_pk_fma_f32 v[58:59], v[82:83], v[22:23], v[18:19]
    v_pk_fma_f32 v[60:61], v[84:85], v[20:21], v[16:17]
    v_pk_fma_f32 v[62:63], v[86:87], v[22:23], v[18:19]
    v_pk_fma_f32 v[64:65], v[88:89], v[20:21], v[16:17]
    v_pk_fma_f32 v[66:67], v[90:91], v[22:23], v[18:19]
    v_pk_fma_f32 v[68:69], v[92:93], v[20:21], v[16:17]
    v_pk_fma_f32 v[70:71], v[94:95], v[22:23], v[18:19]
    v_pk_fma_f32 v[76:77], v[52:53], v[176:177], v[76:77]
    v_pk_fma_f32 v[78:79], v[54:55], v[178:179], v[78:79]
    v_cvt_pk_bf16_f32 v52, v76, v77
    v_cvt_pk_bf16_f32 v53, v78, v79
    ds_write_b64 v14, v[52:53] offset:20480
    v_pk_fma_f32 v[80:81], v[56:57], v[180:181], v[80:81]
    v_pk_fma_f32 v[82:83], v[58:59], v[182:183], v[82:83]
    v_cvt_pk_bf16_f32 v54, v80, v81
    v_cvt_pk_bf16_f32 v55, v82, v83
    ds_write_b64 v14, v[54:55] offset:22528
    v_pk_fma_f32 v[84:85], v[60:61], v[184:185], v[84:85]
    v_pk_fma_f32 v[86:87], v[62:63], v[186:187], v[86:87]
    v_cvt_pk_bf16_f32 v56, v84, v85
    v_cvt_pk_bf16_f32 v57, v86, v87
    ds_write_b64 v14, v[56:57] offset:24576
    v_pk_fma_f32 v[88:89], v[64:65], v[188:189], v[88:89]
    v_pk_fma_f32 v[90:91], v[66:67], v[190:191], v[90:91]
    v_cvt_pk_bf16_f32 v58, v88, v89
    v_cvt_pk_bf16_f32 v59, v90, v91
    ds_write_b64 v14, v[58:59] offset:26624
    v_pk_fma_f32 v[92:93], v[68:69], v[192:193], v[92:93]
    v_pk_fma_f32 v[94:95], v[70:71], v[194:195], v[94:95]
    v_cvt_pk_bf16_f32 v60, v92, v93
    v_cvt_pk_bf16_f32 v61, v94, v95
    ds_write_b64 v14, v[60:61] offset:28672
    s_cmp_eq_u32 s12, 1
    s_cselect_b32 s14, 0, 0x500000
    s_add_u32 s24, s30, s14
    v_add_u32 v10, s31, v2
    s_add_u32 s76, s24, 4096
    s_add_u32 s77, s24, 8192
    s_waitcnt lgkmcnt(0)
    s_barrier
    ds_read_b128 v[64:67], v10 offset:0
    ds_read_b128 v[68:71], v10 offset:4096
    ds_read_b128 v[72:75], v10 offset:8192
    s_waitcnt lgkmcnt(1)
    s_cmp_eq_u32 s12, 1
    s_cbranch_scc1 Lf_81
    buffer_store_dwordx4 v[64:67], v3, s[8:11], s24 offen sc1
    buffer_store_dwordx4 v[68:71], v3, s[8:11], s76 offen sc1
    s_branch Lg_82
Lf_81:
    buffer_store_dwordx4 v[64:67], v3, s[8:11], s24 offen
    buffer_store_dwordx4 v[68:71], v3, s[8:11], s76 offen
Lg_82:
    s_waitcnt lgkmcnt(0)
    s_cmp_ge_u32 s3, 2
    s_cbranch_scc1 L_x3d
    s_cmp_eq_u32 s12, 1
    s_cbranch_scc1 Lf_83
    buffer_store_dwordx4 v[72:75], v3, s[8:11], s77 offen sc1
    s_branch Lg_84
Lf_83:
    buffer_store_dwordx4 v[72:75], v3, s[8:11], s77 offen
Lg_84:
L_x3d:
    s_barrier
    s_mov_b32 s13, 1
    v_accvgpr_read_b32 v2, a240
    v_accvgpr_read_b32 v4, a241
    v_accvgpr_read_b32 v5, a242
    v_accvgpr_read_b32 v6, a243
    v_accvgpr_read_b32 v7, a244
    v_accvgpr_read_b32 v8, a245
    v_accvgpr_read_b32 v9, a246
    v_accvgpr_read_b32 v21, a247
    v_accvgpr_read_b32 v24, a248
    v_accvgpr_read_b32 v26, a249
    v_lshlrev_b32 v20, 4, v1
    v_add_u32 v22, 61440, v8
    v_add_u32 v23, 61440, v9
    s_add_u32 s67, s67, s14
    s_add_u32 s68, s68, s14
    s_add_u32 s69, s69, s14
    s_add_u32 s70, s70, s14
    s_add_u32 s44, s44, 0x10000
    s_add_u32 s45, s45, 0x10000
    s_add_u32 s46, s46, 0x10000
    s_add_u32 s47, s47, 0x10000
    s_add_u32 s48, s48, 0x10000
    s_cmp_eq_u32 s12, 1
    s_cselect_b32 s76, 0, 0x600000
    s_add_u32 s52, s52, s76
    s_add_u32 s53, s53, s76
    s_add_u32 s54, s54, s76
    s_add_u32 s55, s55, s76
    s_sub_u32 s76, s76, 8192
    s_add_u32 s60, s60, s76
    s_add_u32 s61, s61, s76
    s_add_u32 s62, s62, s76
    s_add_u32 s63, s63, s76
    s_add_u32 s65, s65, s14
    s_add_u32 s92, s92, 4
    s_lshl_b32 s76, s5, 4
    s_lshl_b32 s77, s3, 2
    s_add_u32 s76, s76, s77
    s_add_u32 s76, s76, s93
    s_add_u32 s77, s6, 2
    v_mov_b32 v32, s77
    v_mov_b32 v33, 0
    s_waitcnt vmcnt(0)
    s_mov_b64 exec, 1
    s_cmp_eq_u32 s12, 1
    s_cbranch_scc1 Lf_85
    buffer_store_dword v32, v33, s[8:11], s76 offen sc1
    s_branch Lg_86
Lf_85:
    buffer_store_dword v32, v33, s[8:11], s76 offen
Lg_86:
    s_mov_b64 exec, -1
    s_mov_b32 s72, 0x3f803f80
    v_mov_b32 v188, s72
    v_mov_b32 v189, s72
    v_mov_b32 v190, s72
    v_mov_b32 v191, s72
    v_add_u32 v16, s82, v8
    v_add_u32 v17, s82, v9
    v_add_u32 v18, s82, v22
    v_add_u32 v19, s82, v23
    s_add_u32 m0, s64, 0
    s_add_u32 s71, s67, 0
    v_and_b32 v32, 31, v1
    v_lshlrev_b32 v32, 2, v32
    s_lshl_b32 s76, s3, 7
    s_add_u32 s77, s93, s76
    s_add_u32 s76, s6, 2
    s_mov_b32 s79, 0
Lpoll_87:
    buffer_load_dword v33, v32, s[8:11], s77 offen sc1
    s_waitcnt vmcnt(0)
    v_cmp_ne_u32 vcc, s76, v33
    s_cbranch_vccz Lpd_88
    s_add_u32 s79, s79, 1
    s_cmp_lt_u32 s79, s80
    s_cbranch_scc1 Lpoll_87
    s_mov_b32 s80, 0
Lpd_88:
    s_branch L_g1go
L_out:
    v_cvt_pk_bf16_f32 v16, v76, v77
    v_cvt_pk_bf16_f32 v17, v78, v79
    v_cvt_pk_bf16_f32 v18, v80, v81
    v_cvt_pk_bf16_f32 v19, v82, v83
    v_cvt_pk_bf16_f32 v20, v84, v85
    v_cvt_pk_bf16_f32 v21, v86, v87
    v_cvt_pk_bf16_f32 v22, v88, v89
    v_cvt_pk_bf16_f32 v23, v90, v91
    v_cvt_pk_bf16_f32 v24, v92, v93
    v_cvt_pk_bf16_f32 v25, v94, v95
    ds_write_b64 v254, v[16:17] offset:0
    ds_write_b64 v254, v[18:19] offset:512
    ds_write_b64 v254, v[20:21] offset:1024
    ds_write_b64 v254, v[22:23] offset:1536
    ds_write_b64 v254, v[24:25] offset:2048
    ds_read_b64_tr_b16 v[32:33], v255 offset:0
    ds_read_b64_tr_b16 v[34:35], v255 offset:128
    ds_read_b64_tr_b16 v[36:37], v255 offset:1024
    ds_read_b64_tr_b16 v[38:39], v255 offset:1152
    ds_read_b64_tr_b16 v[40:41], v255 offset:2048
    ds_read_b64_tr_b16 v[42:43], v255 offset:2176
    s_mov_b32 s44, s36
    s_and_b32 s45, s37, 0xffff
    s_mov_b32 s46, 0x280000
    s_mov_b32 s47, 0x20000
    v_mul_u32_u24 v10, 208, v8
    v_lshl_add_u32 v10, v9, 4, v10
    v_add_u32 v10, s18, v10
    s_lshl_b32 s20, s16, 6
    s_lshl_b32 s22, s3, 4
    s_add_u32 s20, s20, s22
    s_mul_i32 s20, s20, 1280
    s_mul_i32 s22, s19, 160
    s_add_u32 s20, s20, s22
    v_mul_u32_u24 v14, 208, v96
    v_add3_u32 v16, v14, v100, s18
    v_mul_u32_u24 v14, 1280, v96
    v_add3_u32 v20, v14, v100, s20
    v_mul_u32_u24 v14, 208, v97
    v_add3_u32 v17, v14, v101, s18
    v_mul_u32_u24 v14, 1280, v97
    v_add3_u32 v21, v14, v101, s20
    v_mul_u32_u24 v14, 208, v98
    v_add3_u32 v18, v14, v102, s18
    v_mul_u32_u24 v14, 1280, v98
    v_add3_u32 v22, v14, v102, s20
    s_waitcnt lgkmcnt(0)
    ds_write_b128 v10, v[32:35] offset:0
    ds_write_b128 v10, v[36:39] offset:64
    ds_write_b128 v10, v[40:43] offset:128
    ds_read_b128 v[44:47], v16
    ds_read_b128 v[48:51], v17
    ds_read_b128 v[52:55], v18
    s_waitcnt lgkmcnt(2)
    buffer_store_dwordx4 v[44:47], v20, s[44:47], 0 offen
    s_waitcnt lgkmcnt(1)
    buffer_store_dwordx4 v[48:51], v21, s[44:47], 0 offen
    s_waitcnt lgkmcnt(0)
    s_mov_b32 exec_hi, 0
    buffer_store_dwordx4 v[52:55], v22, s[44:47], 0 offen
    s_mov_b64 exec, -1
L_fin:
L_end:
.set CODE_SPAN, L_end - interleave_layers__ssm_conv_h3__glu_gated_geglu__prompt_kernel - 128
.set CODE_SPAN2, L_end - L_pre - 128
    s_endpgm
.section .rodata,"a"
.p2align 6
.amdhsa_kernel interleave_layers__ssm_conv_h3__glu_gated_geglu__prompt_kernel
  .amdhsa_next_free_vgpr 512
  .amdhsa_next_free_sgpr 102
  .amdhsa_accum_offset 256
  .amdhsa_group_segment_fixed_size 0
  .amdhsa_kernarg_size 104
  .amdhsa_user_sgpr_count 2
  .amdhsa_user_sgpr_kernarg_segment_ptr 1
  .amdhsa_system_sgpr_workgroup_id_x 1
  .amdhsa_float_denorm_mode_32 3
.end_amdhsa_kernel
```
